```python
import torch

def _softmax(x, axis=-1):
    return torch.softmax(x, dim=axis)

def _gelu(x):
    return torch.nn.functional.gelu(x, approximate='tanh')

def _silu(x):
    return torch.nn.functional.silu(x)

def _sigmoid(x):
    return torch.sigmoid(x)

def _layernorm(x, axis=-1, eps=1e-05):
    m = x.mean(dim=axis, keepdim=True)
    v = x.var(dim=axis, keepdim=True, unbiased=False)
    return (x - m) / torch.sqrt(v + eps)

def _scatter_add(tgt, idx, src, axis=0):
    return tgt.clone().index_add_(axis, idx, src)

def _segment_sum(src, seg, n):
    out = torch.zeros((n,) + src.shape[1:], dtype=src.dtype)
    return out.index_add_(0, seg, src)

def _pad(x, pw):
    flat = tuple((v for pair in reversed(pw) for v in pair))
    return torch.nn.functional.pad(x, flat)
kernel_name = 'adaLN_cond__mha_block_cached__dense_activation_silu__decode'

def setup_inputs():

    _w = lambda a: (lambda t: t.to(torch.bfloat16) if t.is_floating_point() else t)(torch.as_tensor(a))

    def _A_setup():
        B, Sq, D = (4, 1, 512)
        H, Sk, Dh = (32, 4096, 128)
        return {'x': _w((lambda *s: torch.randn(*s, dtype=torch.bfloat16) * 0.1)(B, Sq, D)), 'k_cache': _w((lambda *s: torch.randn(*s, dtype=torch.bfloat16) * 0.8)(B, H, Sk, Dh)), 'v_cache': _w((lambda *s: torch.randn(*s, dtype=torch.bfloat16) * 3.2)(B, H, Sk, Dh)), 'wq': _w((lambda *s: torch.randn(*s, dtype=torch.bfloat16) * 0.8)(D, H * Dh) * D ** (-0.5)), 'wo': _w((lambda *s: torch.randn(*s, dtype=torch.bfloat16) * 3.2)(H * Dh, D) * (H * Dh) ** (-0.5))}
    _A_in = _A_setup()

    def _B_setup():
        B, S, D, F = (4, 1, 512, 1792)
        return {'x': _w((lambda *s: torch.randn(*s, dtype=torch.bfloat16) * 0.1)(B, S, D)), 'w1': _w((lambda *s: torch.randn(*s, dtype=torch.bfloat16) * 3.2)(D, F) * D ** (-0.5)), 'w2': _w((lambda *s: torch.randn(*s, dtype=torch.bfloat16) * 3.2)(F, D) * F ** (-0.5))}
    _B_in = _B_setup()
    return {'A_x': _A_in['x'], 'A_k_cache': _A_in['k_cache'], 'A_v_cache': _A_in['v_cache'], 'A_wq': _A_in['wq'], 'A_wo': _A_in['wo'], 'B_x': _B_in['x'], 'B_w1': _B_in['w1'], 'B_w2': _B_in['w2'], 'c': _w((lambda *s: torch.randn(*s, dtype=torch.bfloat16) * 0.1)(4, 512) * 8.0), 'w_mod': _w((lambda *s: torch.randn(*s, dtype=torch.bfloat16) * 0.1)(512, 6 * 512) * 512 ** (-0.5) * 8.0)}

def reference(A_x, A_k_cache, A_v_cache, A_wq, A_wo, B_x, B_w1, B_w2, c, w_mod):

    def _A_ref(x, k_cache, v_cache, wq, wo):
        B, Sq, D = x.shape
        H, Dh = (32, 128)
        q = (lambda x, *d: x.permute(*d))((x @ wq).reshape(B, Sq, H, Dh), 0, 2, 1, 3)
        scores = torch.einsum('bhqd,bhkd->bhqk', q, k_cache) * Dh ** (-0.5)
        p = _softmax(scores, axis=-1)
        o = torch.einsum('bhqk,bhkd->bhqd', p, v_cache)
        return (lambda x, *d: x.permute(*d))(o, 0, 2, 1, 3).reshape(B, Sq, H * Dh) @ wo

    def _B_ref(x, w1, w2):
        h = torch.einsum('bsd,df->bsf', x, w1)
        h = _silu(h)
        out = torch.einsum('bsf,fd->bsd', h, w2)
        return out
    x = A_x
    mod = (_silu(c) @ w_mod).reshape(c.shape[0], 6, 1, -1)
    sa, ca, ga, sb, cb, gb = (mod[:, 0].clone(), mod[:, 1].clone(), mod[:, 2].clone(), mod[:, 3].clone(), mod[:, 4].clone(), mod[:, 5].clone())
    h = _layernorm(x, axis=-1) * (1 + ca) + sa
    x = x + ga * _A_ref(h, A_k_cache, A_v_cache, A_wq, A_wo)
    h = _layernorm(x, axis=-1) * (1 + cb) + sb
    x = x + gb * _B_ref(h, B_w1, B_w2)
    return x
```

```asm
; @launch grid=(256,1,1) block=(768,1,1) lds=163840
.amdgcn_target "amdgcn-amd-amdhsa--gfx950"
.text
.globl adaLN_cond__mha_block_cached__dense_activation_silu__decode_kernel
.p2align 8
.type adaLN_cond__mha_block_cached__dense_activation_silu__decode_kernel,@function
.set NCL, 6
adaLN_cond__mha_block_cached__dense_activation_silu__decode_kernel:
L_beg:
    s_load_dwordx2 s[4:5], s[0:1], 8
    s_load_dwordx2 s[36:37], s[0:1], 72
    s_cmp_ge_u32 s2, 256
    s_cbranch_scc1 L_end
    v_lshrrev_b32 v1, 6, v0
    s_lshr_b32 s51, s2, 3
    s_getpc_b64 s[58:59]
L_pc:
    s_mul_i32 s56, s51, NCL*128
    v_lshl_add_u32 v5, v0, 7, s56
    v_cmp_gt_u32 vcc, NCL, v0
    s_and_b64 exec, exec, vcc
    s_cbranch_execz L_nopf
    global_load_dword v167, v5, s[58:59]
L_nopf:
    s_mov_b64 exec, -1
    v_readfirstlane_b32 s49, v1
    s_and_b32 s50, s2, 7
    s_lshr_b32 s52, s51, 3
    s_bfe_u32 s53, s51, 0x20001
    s_lshl_b32 s56, s50, 2
    s_add_u32 s53, s53, s56
    s_and_b32 s54, s51, 1
    s_cmp_lt_u32 s49, 4
    s_cbranch_scc1 L_helper
    s_mov_b32 s6, 134217728
    s_mov_b32 s7, 0x20000
    s_and_b32 s49, s49, 7
    v_and_b32 v4, 0x1ff, v0
    v_lshlrev_b32 v4, 4, v4
    s_mul_i32 s55, s52, 33685504
    s_lshl_b32 s56, s53, 20
    s_or_b32 s55, s55, s56
    s_lshl_b32 s56, s54, 15
    s_or_b32 s55, s55, s56
    s_mul_i32 s75, s49, 12288
    s_waitcnt lgkmcnt(0)
    s_add_u32 m0, s75, 0
    s_nop 0
    buffer_load_dwordx4 v4, s[4:7], s55 offen nt lds
    s_add_u32 m0, s75, 1024
    s_xor_b32 s56, s55, 8192
    buffer_load_dwordx4 v4, s[4:7], s56 offen nt lds
    s_mov_b32 s38, 3145728
    s_mov_b32 s39, 0x20000
    v_and_b32 v1, 63, v0
    s_and_b32 s3, s2, 1
    s_mul_i32 s3, s3, 24
    s_add_u32 s3, s3, s51
    s_lshr_b32 s61, s50, 1
    v_lshrrev_b32 v8, 3, v1
    v_and_b32 v9, 7, v0
    v_mul_u32_u24 v14, 6144, v8
    v_lshl_add_u32 v14, v9, 4, v14
    s_lshl_b32 s57, s61, 3
    s_add_u32 s57, s57, s49
    s_mul_i32 s57, s57, 98304
    s_lshl_b32 s56, s3, 7
    s_add_u32 s57, s57, s56
    s_add_u32 s59, s57, 49152
    s_lshl_b32 s58, s49, 11
    s_cmp_ge_u32 s51, 24
    s_waitcnt lgkmcnt(0)
    s_cbranch_scc1 L_nop1s
    s_add_u32 m0, s58, 131072
    s_nop 0
    buffer_load_dwordx4 v14, s[36:39], s57 offen  lds
    s_add_u32 m0, s58, 132096
    s_nop 0
    buffer_load_dwordx4 v14, s[36:39], s59 offen  lds
L_nop1s:
    s_add_u32 m0, s75, 2048
    s_xor_b32 s56, s55, 16384
    buffer_load_dwordx4 v4, s[4:7], s56 offen nt lds
    s_load_dwordx2 s[8:9], s[0:1], 16
    s_mov_b32 s10, 134217728
    s_mov_b32 s11, 0x20000
    v_lshrrev_b32 v2, 4, v1
    v_and_b32 v3, 15, v0
    v_and_b32 v6, 1, v0
    v_lshlrev_b32 v6, 4, v6
    v_mov_b32 v7, 0xffff
    v_lshlrev_b32 v6, v6, v7
    v_lshrrev_b32 v7, 1, v3
    v_cmp_eq_u32 vcc, 0, v7
    s_nop 1
    v_cndmask_b32 v8, 0, v6, vcc
    v_cmp_eq_u32 vcc, 1, v7
    s_nop 1
    v_cndmask_b32 v9, 0, v6, vcc
    v_cmp_eq_u32 vcc, 2, v7
    s_nop 1
    v_cndmask_b32 v10, 0, v6, vcc
    v_cmp_eq_u32 vcc, 3, v7
    s_nop 1
    v_cndmask_b32 v11, 0, v6, vcc
    v_lshlrev_b32 v6, 4, v3
    v_add_u32 v6, 153600, v6
    v_lshl_add_u32 v7, v1, 4, s75
    v_mov_b32 v0, 163808
    s_waitcnt vmcnt(2)
    s_add_u32 m0, s75, 3072
    s_xor_b32 s56, s55, 24576
    buffer_load_dwordx4 v4, s[4:7], s56 offen nt lds
    s_waitcnt vmcnt(2)
    s_add_u32 m0, s75, 4096
    s_xor_b32 s56, s55, 65536
    buffer_load_dwordx4 v4, s[4:7], s56 offen nt lds
    s_waitcnt vmcnt(2)
    s_add_u32 m0, s75, 5120
    s_xor_b32 s56, s55, 73728
    buffer_load_dwordx4 v4, s[4:7], s56 offen nt lds
    s_waitcnt vmcnt(3)
    s_barrier
    s_waitcnt vmcnt(3)
    s_add_u32 m0, s75, 6144
    s_xor_b32 s56, s55, 81920
    buffer_load_dwordx4 v4, s[4:7], s56 offen nt lds
    s_waitcnt vmcnt(2)
    s_add_u32 m0, s75, 7168
    s_xor_b32 s56, s55, 90112
    buffer_load_dwordx4 v4, s[4:7], s56 offen nt lds
    s_waitcnt vmcnt(3)
    s_add_u32 m0, s75, 8192
    s_xor_b32 s56, s55, 131072
    buffer_load_dwordx4 v4, s[4:7], s56 offen nt lds
    s_waitcnt vmcnt(2)
    s_add_u32 m0, s75, 9216
    s_xor_b32 s56, s55, 139264
    buffer_load_dwordx4 v4, s[4:7], s56 offen nt lds
    s_waitcnt vmcnt(3)
    s_add_u32 m0, s75, 10240
    s_xor_b32 s56, s55, 147456
    buffer_load_dwordx4 v4, s[4:7], s56 offen nt lds
    s_waitcnt vmcnt(2)
    s_add_u32 m0, s75, 11264
    s_xor_b32 s56, s55, 155648
    buffer_load_dwordx4 v4, s[4:7], s56 offen nt lds
    s_waitcnt vmcnt(3)
    s_xor_b32 s56, s55, 196608
    buffer_load_dwordx4 v[40:43], v4, s[4:7], s56 offen nt
    ds_write_b32 v0, v0
    s_waitcnt vmcnt(2)
    s_xor_b32 s56, s55, 204800
    buffer_load_dwordx4 v[44:47], v4, s[4:7], s56 offen nt
    s_waitcnt vmcnt(3)
    s_xor_b32 s56, s55, 212992
    buffer_load_dwordx4 v[48:51], v4, s[4:7], s56 offen nt
    s_waitcnt vmcnt(2)
    s_xor_b32 s56, s55, 221184
    buffer_load_dwordx4 v[52:55], v4, s[4:7], s56 offen nt
    s_waitcnt vmcnt(3)
    s_xor_b32 s56, s55, 262144
    buffer_load_dwordx4 v[16:19], v4, s[4:7], s56 offen nt
    s_waitcnt vmcnt(2)
    s_xor_b32 s56, s55, 270336
    buffer_load_dwordx4 v[20:23], v4, s[4:7], s56 offen nt
    s_waitcnt vmcnt(3)
    s_xor_b32 s56, s55, 278528
    buffer_load_dwordx4 v[32:35], v4, s[4:7], s56 offen nt
    s_waitcnt vmcnt(2)
    s_xor_b32 s56, s55, 286720
    buffer_load_dwordx4 v[36:39], v4, s[4:7], s56 offen nt
    s_waitcnt vmcnt(3)
    s_xor_b32 s56, s55, 327680
    buffer_load_dwordx4 v[56:59], v4, s[4:7], s56 offen nt
    s_waitcnt vmcnt(2)
    s_xor_b32 s56, s55, 335872
    buffer_load_dwordx4 v[60:63], v4, s[4:7], s56 offen nt
    s_waitcnt vmcnt(3)
    s_xor_b32 s56, s55, 344064
    buffer_load_dwordx4 v[64:67], v4, s[4:7], s56 offen nt
    s_waitcnt vmcnt(2)
    s_xor_b32 s56, s55, 352256
    buffer_load_dwordx4 v[68:71], v4, s[4:7], s56 offen nt
    s_waitcnt vmcnt(3)
    s_xor_b32 s56, s55, 393216
    buffer_load_dwordx4 v[72:75], v4, s[4:7], s56 offen nt
    ds_write_b32 v0, v0 offset:4
    s_waitcnt vmcnt(2)
    s_xor_b32 s56, s55, 401408
    buffer_load_dwordx4 v[76:79], v4, s[4:7], s56 offen nt
    s_waitcnt vmcnt(3)
    s_xor_b32 s56, s55, 409600
    buffer_load_dwordx4 v[80:83], v4, s[4:7], s56 offen nt
    s_waitcnt vmcnt(2)
    s_xor_b32 s56, s55, 417792
    buffer_load_dwordx4 v[84:87], v4, s[4:7], s56 offen nt
    s_waitcnt vmcnt(3)
    s_xor_b32 s56, s55, 458752
    buffer_load_dwordx4 v[88:91], v4, s[4:7], s56 offen nt
    s_waitcnt vmcnt(2)
    s_xor_b32 s56, s55, 466944
    buffer_load_dwordx4 v[92:95], v4, s[4:7], s56 offen nt
    s_waitcnt vmcnt(3)
    s_xor_b32 s56, s55, 475136
    buffer_load_dwordx4 v[96:99], v4, s[4:7], s56 offen nt
    s_waitcnt vmcnt(2)
    s_xor_b32 s56, s55, 483328
    buffer_load_dwordx4 v[100:103], v4, s[4:7], s56 offen nt
    s_waitcnt vmcnt(3)
    s_xor_b32 s56, s55, 524288
    buffer_load_dwordx4 v[104:107], v4, s[4:7], s56 offen nt
    s_waitcnt vmcnt(2)
    s_xor_b32 s56, s55, 532480
    buffer_load_dwordx4 v[108:111], v4, s[4:7], s56 offen nt
    s_waitcnt vmcnt(3)
    s_xor_b32 s56, s55, 540672
    buffer_load_dwordx4 v[112:115], v4, s[4:7], s56 offen nt
    s_waitcnt vmcnt(2)
    s_xor_b32 s56, s55, 548864
    buffer_load_dwordx4 v[116:119], v4, s[4:7], s56 offen nt
    s_waitcnt vmcnt(3)
    s_xor_b32 s56, s55, 589824
    buffer_load_dwordx4 v[120:123], v4, s[4:7], s56 offen nt
    ds_write_b32 v0, v0 offset:8
    s_waitcnt vmcnt(2)
    s_xor_b32 s56, s55, 598016
    buffer_load_dwordx4 v[124:127], v4, s[4:7], s56 offen nt
    s_waitcnt vmcnt(3)
    s_xor_b32 s56, s55, 606208
    buffer_load_dwordx4 v[128:131], v4, s[4:7], s56 offen nt
    s_waitcnt vmcnt(2)
    s_xor_b32 s56, s55, 614400
    buffer_load_dwordx4 v[132:135], v4, s[4:7], s56 offen nt
    s_waitcnt vmcnt(3)
    s_xor_b32 s56, s55, 655360
    buffer_load_dwordx4 v[136:139], v4, s[4:7], s56 offen nt
    s_waitcnt vmcnt(2)
    s_xor_b32 s56, s55, 663552
    buffer_load_dwordx4 v[140:143], v4, s[4:7], s56 offen nt
    s_waitcnt vmcnt(3)
    s_xor_b32 s56, s55, 671744
    buffer_load_dwordx4 v[144:147], v4, s[4:7], s56 offen nt
    s_waitcnt vmcnt(2)
    s_xor_b32 s56, s55, 679936
    buffer_load_dwordx4 v[148:151], v4, s[4:7], s56 offen nt
    s_waitcnt vmcnt(3)
    s_xor_b32 s56, s55, 720896
    buffer_load_dwordx4 v[152:155], v4, s[4:7], s56 offen nt
    s_barrier
    ds_read_b128 v[12:15], v6
    s_waitcnt vmcnt(2)
    s_xor_b32 s56, s55, 729088
    buffer_load_dwordx4 v[156:159], v4, s[4:7], s56 offen nt
    s_waitcnt lgkmcnt(0)
    v_dot2_f32_bf16 v24, v40, v12, 0
    v_dot2_f32_bf16 v25, v44, v12, 0
    v_dot2_f32_bf16 v26, v48, v12, 0
    v_dot2_f32_bf16 v27, v52, v12, 0
    v_dot2_f32_bf16 v24, v41, v13, v24
    v_dot2_f32_bf16 v25, v45, v13, v25
    v_dot2_f32_bf16 v26, v49, v13, v26
    v_dot2_f32_bf16 v27, v53, v13, v27
    v_dot2_f32_bf16 v24, v42, v14, v24
    v_dot2_f32_bf16 v25, v46, v14, v25
    v_dot2_f32_bf16 v26, v50, v14, v26
    v_dot2_f32_bf16 v27, v54, v14, v27
    v_dot2_f32_bf16 v24, v43, v15, v24
    v_dot2_f32_bf16 v25, v47, v15, v25
    v_dot2_f32_bf16 v26, v51, v15, v26
    v_dot2_f32_bf16 v27, v55, v15, v27
    v_add_f32_dpp v28, v24, v24 row_ror:8 row_mask:0xf bank_mask:0x3
    v_add_f32_dpp v28, v25, v25 row_ror:8 row_mask:0xf bank_mask:0xc
    v_add_f32_dpp v29, v26, v26 row_ror:8 row_mask:0xf bank_mask:0x3
    v_add_f32_dpp v29, v27, v27 row_ror:8 row_mask:0xf bank_mask:0xc
    v_add_f32_dpp v30, v28, v28 row_half_mirror row_mask:0xf bank_mask:0x5
    s_nop 0
    v_add_f32_dpp v30, v29, v29 row_half_mirror row_mask:0xf bank_mask:0xa
    s_nop 1
    v_add_f32_dpp v30, v30, v30 quad_perm:[2,3,0,1] row_mask:0xf bank_mask:0xf
    s_nop 1
    v_add_f32_dpp v43, v30, v30 quad_perm:[1,0,3,2] row_mask:0xf bank_mask:0xf
    s_waitcnt vmcnt(3)
    s_xor_b32 s56, s55, 737280
    buffer_load_dwordx4 v[160:163], v4, s[4:7], s56 offen nt
    v_dot2_f32_bf16 v24, v56, v12, 0
    v_dot2_f32_bf16 v25, v60, v12, 0
    v_dot2_f32_bf16 v26, v64, v12, 0
    v_dot2_f32_bf16 v27, v68, v12, 0
    v_dot2_f32_bf16 v24, v57, v13, v24
    v_dot2_f32_bf16 v25, v61, v13, v25
    v_dot2_f32_bf16 v26, v65, v13, v26
    v_dot2_f32_bf16 v27, v69, v13, v27
    v_dot2_f32_bf16 v24, v58, v14, v24
    v_dot2_f32_bf16 v25, v62, v14, v25
    v_dot2_f32_bf16 v26, v66, v14, v26
    v_dot2_f32_bf16 v27, v70, v14, v27
    v_dot2_f32_bf16 v24, v59, v15, v24
    v_dot2_f32_bf16 v25, v63, v15, v25
    v_dot2_f32_bf16 v26, v67, v15, v26
    v_dot2_f32_bf16 v27, v71, v15, v27
    v_add_f32_dpp v28, v24, v24 row_ror:8 row_mask:0xf bank_mask:0x3
    v_add_f32_dpp v28, v25, v25 row_ror:8 row_mask:0xf bank_mask:0xc
    v_add_f32_dpp v29, v26, v26 row_ror:8 row_mask:0xf bank_mask:0x3
    v_add_f32_dpp v29, v27, v27 row_ror:8 row_mask:0xf bank_mask:0xc
    v_add_f32_dpp v30, v28, v28 row_half_mirror row_mask:0xf bank_mask:0x5
    s_nop 0
    v_add_f32_dpp v30, v29, v29 row_half_mirror row_mask:0xf bank_mask:0xa
    s_nop 1
    v_add_f32_dpp v30, v30, v30 quad_perm:[2,3,0,1] row_mask:0xf bank_mask:0xf
    s_nop 1
    v_add_f32_dpp v45, v30, v30 quad_perm:[1,0,3,2] row_mask:0xf bank_mask:0xf
    s_waitcnt vmcnt(2)
    s_xor_b32 s56, s55, 745472
    buffer_load_dwordx4 v[164:167], v4, s[4:7], s56 offen nt
    v_dot2_f32_bf16 v24, v16, v12, 0
    v_dot2_f32_bf16 v25, v20, v12, 0
    v_dot2_f32_bf16 v26, v32, v12, 0
    v_dot2_f32_bf16 v27, v36, v12, 0
    v_dot2_f32_bf16 v24, v17, v13, v24
    v_dot2_f32_bf16 v25, v21, v13, v25
    v_dot2_f32_bf16 v26, v33, v13, v26
    v_dot2_f32_bf16 v27, v37, v13, v27
    v_dot2_f32_bf16 v24, v18, v14, v24
    v_dot2_f32_bf16 v25, v22, v14, v25
    v_dot2_f32_bf16 v26, v34, v14, v26
    v_dot2_f32_bf16 v27, v38, v14, v27
    v_dot2_f32_bf16 v24, v19, v15, v24
    v_dot2_f32_bf16 v25, v23, v15, v25
    v_dot2_f32_bf16 v26, v35, v15, v26
    v_dot2_f32_bf16 v27, v39, v15, v27
    v_add_f32_dpp v28, v24, v24 row_ror:8 row_mask:0xf bank_mask:0x3
    v_add_f32_dpp v28, v25, v25 row_ror:8 row_mask:0xf bank_mask:0xc
    v_add_f32_dpp v29, v26, v26 row_ror:8 row_mask:0xf bank_mask:0x3
    v_add_f32_dpp v29, v27, v27 row_ror:8 row_mask:0xf bank_mask:0xc
    v_add_f32_dpp v30, v28, v28 row_half_mirror row_mask:0xf bank_mask:0x5
    s_nop 0
    v_add_f32_dpp v30, v29, v29 row_half_mirror row_mask:0xf bank_mask:0xa
    s_nop 1
    v_add_f32_dpp v30, v30, v30 quad_perm:[2,3,0,1] row_mask:0xf bank_mask:0xf
    s_nop 1
    v_add_f32_dpp v44, v30, v30 quad_perm:[1,0,3,2] row_mask:0xf bank_mask:0xf
    ds_read_b128 v[16:19], v7 offset:0
    ds_read_b128 v[20:23], v7 offset:1024
    ds_read_b128 v[32:35], v7 offset:2048
    ds_read_b128 v[36:39], v7 offset:3072
    s_waitcnt vmcnt(2)
    s_xor_b32 s56, s55, 786432
    buffer_load_dwordx4 v[56:59], v4, s[4:7], s56 offen nt
    s_waitcnt lgkmcnt(0)
    v_dot2_f32_bf16 v24, v16, v12, 0
    v_dot2_f32_bf16 v25, v20, v12, 0
    v_dot2_f32_bf16 v26, v32, v12, 0
    v_dot2_f32_bf16 v27, v36, v12, 0
    v_dot2_f32_bf16 v24, v17, v13, v24
    v_dot2_f32_bf16 v25, v21, v13, v25
    v_dot2_f32_bf16 v26, v33, v13, v26
    v_dot2_f32_bf16 v27, v37, v13, v27
    v_dot2_f32_bf16 v24, v18, v14, v24
    v_dot2_f32_bf16 v25, v22, v14, v25
    v_dot2_f32_bf16 v26, v34, v14, v26
    v_dot2_f32_bf16 v27, v38, v14, v27
    v_dot2_f32_bf16 v24, v19, v15, v24
    v_dot2_f32_bf16 v25, v23, v15, v25
    v_dot2_f32_bf16 v26, v35, v15, v26
    v_dot2_f32_bf16 v27, v39, v15, v27
    v_add_f32_dpp v28, v24, v24 row_ror:8 row_mask:0xf bank_mask:0x3
    v_add_f32_dpp v28, v25, v25 row_ror:8 row_mask:0xf bank_mask:0xc
    v_add_f32_dpp v29, v26, v26 row_ror:8 row_mask:0xf bank_mask:0x3
    v_add_f32_dpp v29, v27, v27 row_ror:8 row_mask:0xf bank_mask:0xc
    v_add_f32_dpp v30, v28, v28 row_half_mirror row_mask:0xf bank_mask:0x5
    s_nop 0
    v_add_f32_dpp v30, v29, v29 row_half_mirror row_mask:0xf bank_mask:0xa
    s_nop 1
    v_add_f32_dpp v30, v30, v30 quad_perm:[2,3,0,1] row_mask:0xf bank_mask:0xf
    s_nop 1
    v_add_f32_dpp v40, v30, v30 quad_perm:[1,0,3,2] row_mask:0xf bank_mask:0xf
    ds_read_b128 v[16:19], v7 offset:4096
    ds_read_b128 v[20:23], v7 offset:5120
    ds_read_b128 v[32:35], v7 offset:6144
    ds_read_b128 v[36:39], v7 offset:7168
    s_waitcnt vmcnt(2)
    s_xor_b32 s56, s55, 794624
    buffer_load_dwordx4 v[60:63], v4, s[4:7], s56 offen nt
    s_waitcnt lgkmcnt(0)
    v_dot2_f32_bf16 v24, v16, v12, 0
    v_dot2_f32_bf16 v25, v20, v12, 0
    v_dot2_f32_bf16 v26, v32, v12, 0
    v_dot2_f32_bf16 v27, v36, v12, 0
    v_dot2_f32_bf16 v24, v17, v13, v24
    v_dot2_f32_bf16 v25, v21, v13, v25
    v_dot2_f32_bf16 v26, v33, v13, v26
    v_dot2_f32_bf16 v27, v37, v13, v27
    v_dot2_f32_bf16 v24, v18, v14, v24
    v_dot2_f32_bf16 v25, v22, v14, v25
    v_dot2_f32_bf16 v26, v34, v14, v26
    v_dot2_f32_bf16 v27, v38, v14, v27
    v_dot2_f32_bf16 v24, v19, v15, v24
    v_dot2_f32_bf16 v25, v23, v15, v25
    v_dot2_f32_bf16 v26, v35, v15, v26
    v_dot2_f32_bf16 v27, v39, v15, v27
    v_add_f32_dpp v28, v24, v24 row_ror:8 row_mask:0xf bank_mask:0x3
    v_add_f32_dpp v28, v25, v25 row_ror:8 row_mask:0xf bank_mask:0xc
    v_add_f32_dpp v29, v26, v26 row_ror:8 row_mask:0xf bank_mask:0x3
    v_add_f32_dpp v29, v27, v27 row_ror:8 row_mask:0xf bank_mask:0xc
    v_add_f32_dpp v30, v28, v28 row_half_mirror row_mask:0xf bank_mask:0x5
    s_nop 0
    v_add_f32_dpp v30, v29, v29 row_half_mirror row_mask:0xf bank_mask:0xa
    s_nop 1
    v_add_f32_dpp v30, v30, v30 quad_perm:[2,3,0,1] row_mask:0xf bank_mask:0xf
    s_nop 1
    v_add_f32_dpp v41, v30, v30 quad_perm:[1,0,3,2] row_mask:0xf bank_mask:0xf
    ds_read_b128 v[16:19], v7 offset:8192
    ds_read_b128 v[20:23], v7 offset:9216
    ds_read_b128 v[32:35], v7 offset:10240
    ds_read_b128 v[36:39], v7 offset:11264
    s_waitcnt vmcnt(2)
    s_xor_b32 s56, s55, 802816
    buffer_load_dwordx4 v[64:67], v4, s[4:7], s56 offen nt
    s_waitcnt lgkmcnt(0)
    v_dot2_f32_bf16 v24, v16, v12, 0
    v_dot2_f32_bf16 v25, v20, v12, 0
    v_dot2_f32_bf16 v26, v32, v12, 0
    v_dot2_f32_bf16 v27, v36, v12, 0
    v_dot2_f32_bf16 v24, v17, v13, v24
    v_dot2_f32_bf16 v25, v21, v13, v25
    v_dot2_f32_bf16 v26, v33, v13, v26
    v_dot2_f32_bf16 v27, v37, v13, v27
    v_dot2_f32_bf16 v24, v18, v14, v24
    v_dot2_f32_bf16 v25, v22, v14, v25
    v_dot2_f32_bf16 v26, v34, v14, v26
    v_dot2_f32_bf16 v27, v38, v14, v27
    v_dot2_f32_bf16 v24, v19, v15, v24
    v_dot2_f32_bf16 v25, v23, v15, v25
    v_dot2_f32_bf16 v26, v35, v15, v26
    v_dot2_f32_bf16 v27, v39, v15, v27
    v_add_f32_dpp v28, v24, v24 row_ror:8 row_mask:0xf bank_mask:0x3
    v_add_f32_dpp v28, v25, v25 row_ror:8 row_mask:0xf bank_mask:0xc
    v_add_f32_dpp v29, v26, v26 row_ror:8 row_mask:0xf bank_mask:0x3
    v_add_f32_dpp v29, v27, v27 row_ror:8 row_mask:0xf bank_mask:0xc
    v_add_f32_dpp v30, v28, v28 row_half_mirror row_mask:0xf bank_mask:0x5
    s_nop 0
    v_add_f32_dpp v30, v29, v29 row_half_mirror row_mask:0xf bank_mask:0xa
    s_nop 1
    v_add_f32_dpp v30, v30, v30 quad_perm:[2,3,0,1] row_mask:0xf bank_mask:0xf
    s_nop 1
    v_add_f32_dpp v42, v30, v30 quad_perm:[1,0,3,2] row_mask:0xf bank_mask:0xf
    s_barrier
    s_waitcnt vmcnt(2)
    s_xor_b32 s56, s55, 811008
    buffer_load_dwordx4 v[68:71], v4, s[4:7], s56 offen nt
    v_dot2_f32_bf16 v24, v72, v12, 0
    v_dot2_f32_bf16 v25, v76, v12, 0
    v_dot2_f32_bf16 v26, v80, v12, 0
    v_dot2_f32_bf16 v27, v84, v12, 0
    v_dot2_f32_bf16 v24, v73, v13, v24
    v_dot2_f32_bf16 v25, v77, v13, v25
    v_dot2_f32_bf16 v26, v81, v13, v26
    v_dot2_f32_bf16 v27, v85, v13, v27
    v_dot2_f32_bf16 v24, v74, v14, v24
    v_dot2_f32_bf16 v25, v78, v14, v25
    v_dot2_f32_bf16 v26, v82, v14, v26
    v_dot2_f32_bf16 v27, v86, v14, v27
    v_dot2_f32_bf16 v24, v75, v15, v24
    v_dot2_f32_bf16 v25, v79, v15, v25
    v_dot2_f32_bf16 v26, v83, v15, v26
    v_dot2_f32_bf16 v27, v87, v15, v27
    v_add_f32_dpp v28, v24, v24 row_ror:8 row_mask:0xf bank_mask:0x3
    v_add_f32_dpp v28, v25, v25 row_ror:8 row_mask:0xf bank_mask:0xc
    v_add_f32_dpp v29, v26, v26 row_ror:8 row_mask:0xf bank_mask:0x3
    v_add_f32_dpp v29, v27, v27 row_ror:8 row_mask:0xf bank_mask:0xc
    v_add_f32_dpp v30, v28, v28 row_half_mirror row_mask:0xf bank_mask:0x5
    s_nop 0
    v_add_f32_dpp v30, v29, v29 row_half_mirror row_mask:0xf bank_mask:0xa
    s_nop 1
    v_add_f32_dpp v30, v30, v30 quad_perm:[2,3,0,1] row_mask:0xf bank_mask:0xf
    s_nop 1
    v_add_f32_dpp v46, v30, v30 quad_perm:[1,0,3,2] row_mask:0xf bank_mask:0xf
    s_waitcnt vmcnt(2)
    s_xor_b32 s56, s55, 851968
    buffer_load_dwordx4 v[72:75], v4, s[4:7], s56 offen nt
    v_dot2_f32_bf16 v24, v88, v12, 0
    v_dot2_f32_bf16 v25, v92, v12, 0
    v_dot2_f32_bf16 v26, v96, v12, 0
    v_dot2_f32_bf16 v27, v100, v12, 0
    v_dot2_f32_bf16 v24, v89, v13, v24
    v_dot2_f32_bf16 v25, v93, v13, v25
    v_dot2_f32_bf16 v26, v97, v13, v26
    v_dot2_f32_bf16 v27, v101, v13, v27
    v_dot2_f32_bf16 v24, v90, v14, v24
    v_dot2_f32_bf16 v25, v94, v14, v25
    v_dot2_f32_bf16 v26, v98, v14, v26
    v_dot2_f32_bf16 v27, v102, v14, v27
    v_dot2_f32_bf16 v24, v91, v15, v24
    v_dot2_f32_bf16 v25, v95, v15, v25
    v_dot2_f32_bf16 v26, v99, v15, v26
    v_dot2_f32_bf16 v27, v103, v15, v27
    v_add_f32_dpp v28, v24, v24 row_ror:8 row_mask:0xf bank_mask:0x3
    v_add_f32_dpp v28, v25, v25 row_ror:8 row_mask:0xf bank_mask:0xc
    v_add_f32_dpp v29, v26, v26 row_ror:8 row_mask:0xf bank_mask:0x3
    v_add_f32_dpp v29, v27, v27 row_ror:8 row_mask:0xf bank_mask:0xc
    v_add_f32_dpp v30, v28, v28 row_half_mirror row_mask:0xf bank_mask:0x5
    s_nop 0
    v_add_f32_dpp v30, v29, v29 row_half_mirror row_mask:0xf bank_mask:0xa
    s_nop 1
    v_add_f32_dpp v30, v30, v30 quad_perm:[2,3,0,1] row_mask:0xf bank_mask:0xf
    s_nop 1
    v_add_f32_dpp v47, v30, v30 quad_perm:[1,0,3,2] row_mask:0xf bank_mask:0xf
    s_waitcnt vmcnt(2)
    s_xor_b32 s56, s55, 860160
    buffer_load_dwordx4 v[76:79], v4, s[4:7], s56 offen nt
    v_dot2_f32_bf16 v24, v104, v12, 0
    v_dot2_f32_bf16 v25, v108, v12, 0
    v_dot2_f32_bf16 v26, v112, v12, 0
    v_dot2_f32_bf16 v27, v116, v12, 0
    v_dot2_f32_bf16 v24, v105, v13, v24
    v_dot2_f32_bf16 v25, v109, v13, v25
    v_dot2_f32_bf16 v26, v113, v13, v26
    v_dot2_f32_bf16 v27, v117, v13, v27
    v_dot2_f32_bf16 v24, v106, v14, v24
    v_dot2_f32_bf16 v25, v110, v14, v25
    v_dot2_f32_bf16 v26, v114, v14, v26
    v_dot2_f32_bf16 v27, v118, v14, v27
    v_dot2_f32_bf16 v24, v107, v15, v24
    v_dot2_f32_bf16 v25, v111, v15, v25
    v_dot2_f32_bf16 v26, v115, v15, v26
    v_dot2_f32_bf16 v27, v119, v15, v27
    v_add_f32_dpp v28, v24, v24 row_ror:8 row_mask:0xf bank_mask:0x3
    v_add_f32_dpp v28, v25, v25 row_ror:8 row_mask:0xf bank_mask:0xc
    v_add_f32_dpp v29, v26, v26 row_ror:8 row_mask:0xf bank_mask:0x3
    v_add_f32_dpp v29, v27, v27 row_ror:8 row_mask:0xf bank_mask:0xc
    v_add_f32_dpp v30, v28, v28 row_half_mirror row_mask:0xf bank_mask:0x5
    s_nop 0
    v_add_f32_dpp v30, v29, v29 row_half_mirror row_mask:0xf bank_mask:0xa
    s_nop 1
    v_add_f32_dpp v30, v30, v30 quad_perm:[2,3,0,1] row_mask:0xf bank_mask:0xf
    s_nop 1
    v_add_f32_dpp v48, v30, v30 quad_perm:[1,0,3,2] row_mask:0xf bank_mask:0xf
    s_waitcnt vmcnt(2)
    s_xor_b32 s56, s55, 868352
    buffer_load_dwordx4 v[80:83], v4, s[4:7], s56 offen nt
    v_dot2_f32_bf16 v24, v120, v12, 0
    v_dot2_f32_bf16 v25, v124, v12, 0
    v_dot2_f32_bf16 v26, v128, v12, 0
    v_dot2_f32_bf16 v27, v132, v12, 0
    v_dot2_f32_bf16 v24, v121, v13, v24
    v_dot2_f32_bf16 v25, v125, v13, v25
    v_dot2_f32_bf16 v26, v129, v13, v26
    v_dot2_f32_bf16 v27, v133, v13, v27
    v_dot2_f32_bf16 v24, v122, v14, v24
    v_dot2_f32_bf16 v25, v126, v14, v25
    v_dot2_f32_bf16 v26, v130, v14, v26
    v_dot2_f32_bf16 v27, v134, v14, v27
    v_dot2_f32_bf16 v24, v123, v15, v24
    v_dot2_f32_bf16 v25, v127, v15, v25
    v_dot2_f32_bf16 v26, v131, v15, v26
    v_dot2_f32_bf16 v27, v135, v15, v27
    v_add_f32_dpp v28, v24, v24 row_ror:8 row_mask:0xf bank_mask:0x3
    v_add_f32_dpp v28, v25, v25 row_ror:8 row_mask:0xf bank_mask:0xc
    v_add_f32_dpp v29, v26, v26 row_ror:8 row_mask:0xf bank_mask:0x3
    v_add_f32_dpp v29, v27, v27 row_ror:8 row_mask:0xf bank_mask:0xc
    v_add_f32_dpp v30, v28, v28 row_half_mirror row_mask:0xf bank_mask:0x5
    s_nop 0
    v_add_f32_dpp v30, v29, v29 row_half_mirror row_mask:0xf bank_mask:0xa
    s_nop 1
    v_add_f32_dpp v30, v30, v30 quad_perm:[2,3,0,1] row_mask:0xf bank_mask:0xf
    s_nop 1
    v_add_f32_dpp v49, v30, v30 quad_perm:[1,0,3,2] row_mask:0xf bank_mask:0xf
    s_waitcnt vmcnt(2)
    s_xor_b32 s56, s55, 876544
    buffer_load_dwordx4 v[84:87], v4, s[4:7], s56 offen nt
    v_dot2_f32_bf16 v24, v136, v12, 0
    v_dot2_f32_bf16 v25, v140, v12, 0
    v_dot2_f32_bf16 v26, v144, v12, 0
    v_dot2_f32_bf16 v27, v148, v12, 0
    v_dot2_f32_bf16 v24, v137, v13, v24
    v_dot2_f32_bf16 v25, v141, v13, v25
    v_dot2_f32_bf16 v26, v145, v13, v26
    v_dot2_f32_bf16 v27, v149, v13, v27
    v_dot2_f32_bf16 v24, v138, v14, v24
    v_dot2_f32_bf16 v25, v142, v14, v25
    v_dot2_f32_bf16 v26, v146, v14, v26
    v_dot2_f32_bf16 v27, v150, v14, v27
    v_dot2_f32_bf16 v24, v139, v15, v24
    v_dot2_f32_bf16 v25, v143, v15, v25
    v_dot2_f32_bf16 v26, v147, v15, v26
    v_dot2_f32_bf16 v27, v151, v15, v27
    v_add_f32_dpp v28, v24, v24 row_ror:8 row_mask:0xf bank_mask:0x3
    v_add_f32_dpp v28, v25, v25 row_ror:8 row_mask:0xf bank_mask:0xc
    v_add_f32_dpp v29, v26, v26 row_ror:8 row_mask:0xf bank_mask:0x3
    v_add_f32_dpp v29, v27, v27 row_ror:8 row_mask:0xf bank_mask:0xc
    v_add_f32_dpp v30, v28, v28 row_half_mirror row_mask:0xf bank_mask:0x5
    s_nop 0
    v_add_f32_dpp v30, v29, v29 row_half_mirror row_mask:0xf bank_mask:0xa
    s_nop 1
    v_add_f32_dpp v30, v30, v30 quad_perm:[2,3,0,1] row_mask:0xf bank_mask:0xf
    s_nop 1
    v_add_f32_dpp v50, v30, v30 quad_perm:[1,0,3,2] row_mask:0xf bank_mask:0xf
    s_waitcnt vmcnt(2)
    s_xor_b32 s56, s55, 917504
    buffer_load_dwordx4 v[88:91], v4, s[4:7], s56 offen nt
    v_dot2_f32_bf16 v24, v152, v12, 0
    v_dot2_f32_bf16 v25, v156, v12, 0
    v_dot2_f32_bf16 v26, v160, v12, 0
    v_dot2_f32_bf16 v27, v164, v12, 0
    v_dot2_f32_bf16 v24, v153, v13, v24
    v_dot2_f32_bf16 v25, v157, v13, v25
    v_dot2_f32_bf16 v26, v161, v13, v26
    v_dot2_f32_bf16 v27, v165, v13, v27
    v_dot2_f32_bf16 v24, v154, v14, v24
    v_dot2_f32_bf16 v25, v158, v14, v25
    v_dot2_f32_bf16 v26, v162, v14, v26
    v_dot2_f32_bf16 v27, v166, v14, v27
    v_dot2_f32_bf16 v24, v155, v15, v24
    v_dot2_f32_bf16 v25, v159, v15, v25
    v_dot2_f32_bf16 v26, v163, v15, v26
    v_dot2_f32_bf16 v27, v167, v15, v27
    v_add_f32_dpp v28, v24, v24 row_ror:8 row_mask:0xf bank_mask:0x3
    v_add_f32_dpp v28, v25, v25 row_ror:8 row_mask:0xf bank_mask:0xc
    v_add_f32_dpp v29, v26, v26 row_ror:8 row_mask:0xf bank_mask:0x3
    v_add_f32_dpp v29, v27, v27 row_ror:8 row_mask:0xf bank_mask:0xc
    v_add_f32_dpp v30, v28, v28 row_half_mirror row_mask:0xf bank_mask:0x5
    s_nop 0
    v_add_f32_dpp v30, v29, v29 row_half_mirror row_mask:0xf bank_mask:0xa
    s_nop 1
    v_add_f32_dpp v30, v30, v30 quad_perm:[2,3,0,1] row_mask:0xf bank_mask:0xf
    s_nop 1
    v_add_f32_dpp v51, v30, v30 quad_perm:[1,0,3,2] row_mask:0xf bank_mask:0xf
    s_waitcnt vmcnt(2)
    s_xor_b32 s56, s55, 925696
    buffer_load_dwordx4 v[92:95], v4, s[4:7], s56 offen nt
    v_dot2_f32_bf16 v24, v56, v12, 0
    v_dot2_f32_bf16 v25, v60, v12, 0
    v_dot2_f32_bf16 v26, v64, v12, 0
    v_dot2_f32_bf16 v27, v68, v12, 0
    v_dot2_f32_bf16 v24, v57, v13, v24
    v_dot2_f32_bf16 v25, v61, v13, v25
    v_dot2_f32_bf16 v26, v65, v13, v26
    v_dot2_f32_bf16 v27, v69, v13, v27
    v_dot2_f32_bf16 v24, v58, v14, v24
    v_dot2_f32_bf16 v25, v62, v14, v25
    v_dot2_f32_bf16 v26, v66, v14, v26
    v_dot2_f32_bf16 v27, v70, v14, v27
    v_dot2_f32_bf16 v24, v59, v15, v24
    v_dot2_f32_bf16 v25, v63, v15, v25
    v_dot2_f32_bf16 v26, v67, v15, v26
    v_dot2_f32_bf16 v27, v71, v15, v27
    v_add_f32_dpp v28, v24, v24 row_ror:8 row_mask:0xf bank_mask:0x3
    v_add_f32_dpp v28, v25, v25 row_ror:8 row_mask:0xf bank_mask:0xc
    v_add_f32_dpp v29, v26, v26 row_ror:8 row_mask:0xf bank_mask:0x3
    v_add_f32_dpp v29, v27, v27 row_ror:8 row_mask:0xf bank_mask:0xc
    v_add_f32_dpp v30, v28, v28 row_half_mirror row_mask:0xf bank_mask:0x5
    s_nop 0
    v_add_f32_dpp v30, v29, v29 row_half_mirror row_mask:0xf bank_mask:0xa
    s_nop 1
    v_add_f32_dpp v30, v30, v30 quad_perm:[2,3,0,1] row_mask:0xf bank_mask:0xf
    s_nop 1
    v_add_f32_dpp v52, v30, v30 quad_perm:[1,0,3,2] row_mask:0xf bank_mask:0xf
    s_waitcnt vmcnt(2)
    s_xor_b32 s56, s55, 933888
    buffer_load_dwordx4 v[96:99], v4, s[4:7], s56 offen nt
    v_dot2_f32_bf16 v24, v72, v12, 0
    v_dot2_f32_bf16 v25, v76, v12, 0
    v_dot2_f32_bf16 v26, v80, v12, 0
    v_dot2_f32_bf16 v27, v84, v12, 0
    v_dot2_f32_bf16 v24, v73, v13, v24
    v_dot2_f32_bf16 v25, v77, v13, v25
    v_dot2_f32_bf16 v26, v81, v13, v26
    v_dot2_f32_bf16 v27, v85, v13, v27
    v_dot2_f32_bf16 v24, v74, v14, v24
    v_dot2_f32_bf16 v25, v78, v14, v25
    v_dot2_f32_bf16 v26, v82, v14, v26
    v_dot2_f32_bf16 v27, v86, v14, v27
    v_dot2_f32_bf16 v24, v75, v15, v24
    v_dot2_f32_bf16 v25, v79, v15, v25
    v_dot2_f32_bf16 v26, v83, v15, v26
    v_dot2_f32_bf16 v27, v87, v15, v27
    v_add_f32_dpp v28, v24, v24 row_ror:8 row_mask:0xf bank_mask:0x3
    v_add_f32_dpp v28, v25, v25 row_ror:8 row_mask:0xf bank_mask:0xc
    v_add_f32_dpp v29, v26, v26 row_ror:8 row_mask:0xf bank_mask:0x3
    v_add_f32_dpp v29, v27, v27 row_ror:8 row_mask:0xf bank_mask:0xc
    v_add_f32_dpp v30, v28, v28 row_half_mirror row_mask:0xf bank_mask:0x5
    s_nop 0
    v_add_f32_dpp v30, v29, v29 row_half_mirror row_mask:0xf bank_mask:0xa
    s_nop 1
    v_add_f32_dpp v30, v30, v30 quad_perm:[2,3,0,1] row_mask:0xf bank_mask:0xf
    s_nop 1
    v_add_f32_dpp v53, v30, v30 quad_perm:[1,0,3,2] row_mask:0xf bank_mask:0xf
    s_waitcnt vmcnt(2)
    s_xor_b32 s56, s55, 942080
    buffer_load_dwordx4 v[100:103], v4, s[4:7], s56 offen nt
    s_waitcnt vmcnt(2)
    s_xor_b32 s56, s55, 983040
    buffer_load_dwordx4 v[104:107], v4, s[4:7], s56 offen nt
    s_waitcnt vmcnt(2)
    s_xor_b32 s56, s55, 991232
    buffer_load_dwordx4 v[108:111], v4, s[4:7], s56 offen nt
    s_waitcnt vmcnt(2)
    s_xor_b32 s56, s55, 999424
    buffer_load_dwordx4 v[112:115], v4, s[4:7], s56 offen nt
    v_dot2_f32_bf16 v24, v88, v12, 0
    v_dot2_f32_bf16 v25, v92, v12, 0
    v_dot2_f32_bf16 v26, v96, v12, 0
    v_dot2_f32_bf16 v27, v100, v12, 0
    v_dot2_f32_bf16 v24, v89, v13, v24
    v_dot2_f32_bf16 v25, v93, v13, v25
    v_dot2_f32_bf16 v26, v97, v13, v26
    v_dot2_f32_bf16 v27, v101, v13, v27
    v_dot2_f32_bf16 v24, v90, v14, v24
    v_dot2_f32_bf16 v25, v94, v14, v25
    v_dot2_f32_bf16 v26, v98, v14, v26
    v_dot2_f32_bf16 v27, v102, v14, v27
    v_dot2_f32_bf16 v24, v91, v15, v24
    v_dot2_f32_bf16 v25, v95, v15, v25
    v_dot2_f32_bf16 v26, v99, v15, v26
    v_dot2_f32_bf16 v27, v103, v15, v27
    v_add_f32_dpp v28, v24, v24 row_ror:8 row_mask:0xf bank_mask:0x3
    v_add_f32_dpp v28, v25, v25 row_ror:8 row_mask:0xf bank_mask:0xc
    v_add_f32_dpp v29, v26, v26 row_ror:8 row_mask:0xf bank_mask:0x3
    v_add_f32_dpp v29, v27, v27 row_ror:8 row_mask:0xf bank_mask:0xc
    v_add_f32_dpp v30, v28, v28 row_half_mirror row_mask:0xf bank_mask:0x5
    s_nop 0
    v_add_f32_dpp v30, v29, v29 row_half_mirror row_mask:0xf bank_mask:0xa
    s_nop 1
    v_add_f32_dpp v30, v30, v30 quad_perm:[2,3,0,1] row_mask:0xf bank_mask:0xf
    s_nop 1
    v_add_f32_dpp v54, v30, v30 quad_perm:[1,0,3,2] row_mask:0xf bank_mask:0xf
    s_waitcnt vmcnt(2)
    s_xor_b32 s56, s55, 1007616
    buffer_load_dwordx4 v[116:119], v4, s[4:7], s56 offen nt
    s_waitcnt vmcnt(2)
    buffer_load_dwordx4 v[120:123], v4, s[8:11], s55 offen nt
    s_waitcnt vmcnt(2)
    s_xor_b32 s56, s55, 8192
    buffer_load_dwordx4 v[124:127], v4, s[8:11], s56 offen nt
    s_waitcnt vmcnt(2)
    s_xor_b32 s56, s55, 16384
    buffer_load_dwordx4 v[128:131], v4, s[8:11], s56 offen nt
    v_dot2_f32_bf16 v24, v104, v12, 0
    v_dot2_f32_bf16 v25, v108, v12, 0
    v_dot2_f32_bf16 v26, v112, v12, 0
    v_dot2_f32_bf16 v27, v116, v12, 0
    v_dot2_f32_bf16 v24, v105, v13, v24
    v_dot2_f32_bf16 v25, v109, v13, v25
    v_dot2_f32_bf16 v26, v113, v13, v26
    v_dot2_f32_bf16 v27, v117, v13, v27
    v_dot2_f32_bf16 v24, v106, v14, v24
    v_dot2_f32_bf16 v25, v110, v14, v25
    v_dot2_f32_bf16 v26, v114, v14, v26
    v_dot2_f32_bf16 v27, v118, v14, v27
    v_dot2_f32_bf16 v24, v107, v15, v24
    v_dot2_f32_bf16 v25, v111, v15, v25
    v_dot2_f32_bf16 v26, v115, v15, v26
    v_dot2_f32_bf16 v27, v119, v15, v27
    v_add_f32_dpp v28, v24, v24 row_ror:8 row_mask:0xf bank_mask:0x3
    v_add_f32_dpp v28, v25, v25 row_ror:8 row_mask:0xf bank_mask:0xc
    v_add_f32_dpp v29, v26, v26 row_ror:8 row_mask:0xf bank_mask:0x3
    v_add_f32_dpp v29, v27, v27 row_ror:8 row_mask:0xf bank_mask:0xc
    v_add_f32_dpp v30, v28, v28 row_half_mirror row_mask:0xf bank_mask:0x5
    s_nop 0
    v_add_f32_dpp v30, v29, v29 row_half_mirror row_mask:0xf bank_mask:0xa
    s_nop 1
    v_add_f32_dpp v30, v30, v30 quad_perm:[2,3,0,1] row_mask:0xf bank_mask:0xf
    s_nop 1
    v_add_f32_dpp v55, v30, v30 quad_perm:[1,0,3,2] row_mask:0xf bank_mask:0xf
    s_waitcnt vmcnt(2)
    s_xor_b32 s56, s55, 24576
    buffer_load_dwordx4 v[132:135], v4, s[8:11], s56 offen nt
    v_max3_f32 v5, v40, v41, v42
    v_max3_f32 v6, v43, v44, v45
    v_max3_f32 v5, v5, v46, v47
    v_max3_f32 v6, v6, v48, v49
    v_max3_f32 v5, v5, v50, v51
    v_max3_f32 v6, v6, v52, v53
    v_max3_f32 v5, v5, v54, v55
    v_max_f32 v5, v5, v6
    s_nop 1
    v_max_f32_dpp v5, v5, v5 row_half_mirror row_mask:0xf bank_mask:0xf
    s_nop 1
    v_max_f32_dpp v5, v5, v5 row_ror:8 row_mask:0xf bank_mask:0xf
    v_mov_b32 v6, v5
    s_nop 1
    v_permlane16_swap_b32 v5, v6
    v_max_f32 v5, v5, v6
    v_mov_b32 v6, v5
    s_nop 1
    v_permlane32_swap_b32 v5, v6
    v_max_f32 v5, v5, v6
    s_mov_b32 s57, 0x3e0293ee
    v_mul_f32 v5, s57, v5
    s_waitcnt vmcnt(2)
    s_xor_b32 s56, s55, 65536
    buffer_load_dwordx4 v[136:139], v4, s[8:11], s56 offen nt
    v_fma_f32 v40, v40, s57, -v5
    v_fma_f32 v41, v41, s57, -v5
    v_fma_f32 v42, v42, s57, -v5
    v_fma_f32 v43, v43, s57, -v5
    v_fma_f32 v44, v44, s57, -v5
    v_fma_f32 v45, v45, s57, -v5
    v_fma_f32 v46, v46, s57, -v5
    v_fma_f32 v47, v47, s57, -v5
    v_fma_f32 v48, v48, s57, -v5
    v_fma_f32 v49, v49, s57, -v5
    v_fma_f32 v50, v50, s57, -v5
    v_fma_f32 v51, v51, s57, -v5
    v_fma_f32 v52, v52, s57, -v5
    v_fma_f32 v53, v53, s57, -v5
    v_fma_f32 v54, v54, s57, -v5
    v_fma_f32 v55, v55, s57, -v5
    v_exp_f32 v40, v40
    v_exp_f32 v41, v41
    v_exp_f32 v42, v42
    v_exp_f32 v43, v43
    v_exp_f32 v44, v44
    v_exp_f32 v45, v45
    v_exp_f32 v46, v46
    v_exp_f32 v47, v47
    v_exp_f32 v48, v48
    v_exp_f32 v49, v49
    v_exp_f32 v50, v50
    v_exp_f32 v51, v51
    v_exp_f32 v52, v52
    v_exp_f32 v53, v53
    v_exp_f32 v54, v54
    v_exp_f32 v55, v55
    s_waitcnt vmcnt(2)
    s_xor_b32 s56, s55, 73728
    buffer_load_dwordx4 v[140:143], v4, s[8:11], s56 offen nt
    v_pk_add_f32 v[34:35], v[40:41], v[42:43]
    v_pk_add_f32 v[34:35], v[34:35], v[44:45]
    v_pk_add_f32 v[34:35], v[34:35], v[46:47]
    v_pk_add_f32 v[34:35], v[34:35], v[48:49]
    v_pk_add_f32 v[34:35], v[34:35], v[50:51]
    v_pk_add_f32 v[34:35], v[34:35], v[52:53]
    v_pk_add_f32 v[34:35], v[34:35], v[54:55]
    v_add_f32 v34, v34, v35
    v_cvt_pk_bf16_f32 v40, v40, v40
    v_cvt_pk_bf16_f32 v41, v41, v41
    v_cvt_pk_bf16_f32 v42, v42, v42
    v_cvt_pk_bf16_f32 v43, v43, v43
    v_cvt_pk_bf16_f32 v44, v44, v44
    v_cvt_pk_bf16_f32 v45, v45, v45
    v_cvt_pk_bf16_f32 v46, v46, v46
    v_cvt_pk_bf16_f32 v47, v47, v47
    v_cvt_pk_bf16_f32 v48, v48, v48
    v_cvt_pk_bf16_f32 v49, v49, v49
    v_cvt_pk_bf16_f32 v50, v50, v50
    v_cvt_pk_bf16_f32 v51, v51, v51
    v_cvt_pk_bf16_f32 v52, v52, v52
    v_cvt_pk_bf16_f32 v53, v53, v53
    v_cvt_pk_bf16_f32 v54, v54, v54
    v_cvt_pk_bf16_f32 v55, v55, v55
    s_waitcnt vmcnt(2)
    s_xor_b32 s56, s55, 81920
    buffer_load_dwordx4 v[144:147], v4, s[8:11], s56 offen nt
    v_add_f32_dpp v34, v34, v34 row_half_mirror row_mask:0xf bank_mask:0xf
    s_nop 1
    v_add_f32_dpp v34, v34, v34 row_ror:8 row_mask:0xf bank_mask:0xf
    v_mov_b32 v6, v34
    s_nop 1
    v_permlane16_swap_b32 v34, v6
    v_add_f32 v34, v34, v6
    v_mov_b32 v6, v34
    s_nop 1
    v_permlane32_swap_b32 v34, v6
    v_add_f32 v34, v34, v6
    v_mov_b32 v32, v5
    v_mov_b32 v33, v34
    s_lshl_b32 s56, s49, 3
    s_add_u32 s56, s56, 163712
    v_mov_b32 v6, s56
    v_mov_b32 v7, 1
    s_mov_b64 exec, 1
    ds_write_b64 v6, v[32:33]
    ds_add_u32 v0, v7 offset:16
    s_mov_b64 exec, -1
    s_mul_i32 s56, s49, 272
    s_add_u32 s56, s56, 157696
    v_lshl_add_u32 v6, v3, 4, s56
    v_lshl_add_u32 v6, v2, 3, v6
    s_waitcnt vmcnt(2)
    s_xor_b32 s56, s55, 90112
    buffer_load_dwordx4 v[148:151], v4, s[8:11], s56 offen nt
    v_and_b32_dpp v24, v40, v8 row_newbcast:0 row_mask:0xf bank_mask:0xf
    v_and_b32_dpp v25, v40, v9 row_newbcast:0 row_mask:0xf bank_mask:0xf
    v_and_b32_dpp v26, v40, v10 row_newbcast:0 row_mask:0xf bank_mask:0xf
    v_and_b32_dpp v27, v40, v11 row_newbcast:0 row_mask:0xf bank_mask:0xf
    s_nop 1
    v_mfma_f32_16x16x32_bf16 v[20:23], v[24:27], v[120:123], 0
    v_and_b32_dpp v28, v40, v8 row_newbcast:8 row_mask:0xf bank_mask:0xf
    v_and_b32_dpp v29, v40, v9 row_newbcast:8 row_mask:0xf bank_mask:0xf
    v_and_b32_dpp v30, v40, v10 row_newbcast:8 row_mask:0xf bank_mask:0xf
    v_and_b32_dpp v31, v40, v11 row_newbcast:8 row_mask:0xf bank_mask:0xf
    s_nop 1
    v_mfma_f32_16x16x32_bf16 v[20:23], v[28:31], v[124:127], v[20:23]
    s_waitcnt vmcnt(2)
    s_xor_b32 s56, s55, 131072
    buffer_load_dwordx4 v[152:155], v4, s[8:11], s56 offen nt
    v_and_b32_dpp v24, v40, v8 row_newbcast:4 row_mask:0xf bank_mask:0xf
    v_and_b32_dpp v25, v40, v9 row_newbcast:4 row_mask:0xf bank_mask:0xf
    v_and_b32_dpp v26, v40, v10 row_newbcast:4 row_mask:0xf bank_mask:0xf
    v_and_b32_dpp v27, v40, v11 row_newbcast:4 row_mask:0xf bank_mask:0xf
    s_nop 1
    v_mfma_f32_16x16x32_bf16 v[20:23], v[24:27], v[128:131], v[20:23]
    v_and_b32_dpp v28, v40, v8 row_newbcast:12 row_mask:0xf bank_mask:0xf
    v_and_b32_dpp v29, v40, v9 row_newbcast:12 row_mask:0xf bank_mask:0xf
    v_and_b32_dpp v30, v40, v10 row_newbcast:12 row_mask:0xf bank_mask:0xf
    v_and_b32_dpp v31, v40, v11 row_newbcast:12 row_mask:0xf bank_mask:0xf
    s_nop 1
    v_mfma_f32_16x16x32_bf16 v[20:23], v[28:31], v[132:135], v[20:23]
    s_waitcnt vmcnt(2)
    s_xor_b32 s56, s55, 139264
    buffer_load_dwordx4 v[156:159], v4, s[8:11], s56 offen nt
    v_and_b32_dpp v24, v41, v8 row_newbcast:0 row_mask:0xf bank_mask:0xf
    v_and_b32_dpp v25, v41, v9 row_newbcast:0 row_mask:0xf bank_mask:0xf
    v_and_b32_dpp v26, v41, v10 row_newbcast:0 row_mask:0xf bank_mask:0xf
    v_and_b32_dpp v27, v41, v11 row_newbcast:0 row_mask:0xf bank_mask:0xf
    s_nop 1
    v_mfma_f32_16x16x32_bf16 v[20:23], v[24:27], v[136:139], v[20:23]
    v_and_b32_dpp v28, v41, v8 row_newbcast:8 row_mask:0xf bank_mask:0xf
    v_and_b32_dpp v29, v41, v9 row_newbcast:8 row_mask:0xf bank_mask:0xf
    v_and_b32_dpp v30, v41, v10 row_newbcast:8 row_mask:0xf bank_mask:0xf
    v_and_b32_dpp v31, v41, v11 row_newbcast:8 row_mask:0xf bank_mask:0xf
    s_nop 1
    v_mfma_f32_16x16x32_bf16 v[20:23], v[28:31], v[140:143], v[20:23]
    s_waitcnt vmcnt(2)
    s_xor_b32 s56, s55, 147456
    buffer_load_dwordx4 v[160:163], v4, s[8:11], s56 offen nt
    v_and_b32_dpp v24, v41, v8 row_newbcast:4 row_mask:0xf bank_mask:0xf
    v_and_b32_dpp v25, v41, v9 row_newbcast:4 row_mask:0xf bank_mask:0xf
    v_and_b32_dpp v26, v41, v10 row_newbcast:4 row_mask:0xf bank_mask:0xf
    v_and_b32_dpp v27, v41, v11 row_newbcast:4 row_mask:0xf bank_mask:0xf
    s_nop 1
    v_mfma_f32_16x16x32_bf16 v[20:23], v[24:27], v[144:147], v[20:23]
    v_and_b32_dpp v28, v41, v8 row_newbcast:12 row_mask:0xf bank_mask:0xf
    v_and_b32_dpp v29, v41, v9 row_newbcast:12 row_mask:0xf bank_mask:0xf
    v_and_b32_dpp v30, v41, v10 row_newbcast:12 row_mask:0xf bank_mask:0xf
    v_and_b32_dpp v31, v41, v11 row_newbcast:12 row_mask:0xf bank_mask:0xf
    s_nop 1
    v_mfma_f32_16x16x32_bf16 v[20:23], v[28:31], v[148:151], v[20:23]
    s_waitcnt vmcnt(2)
    s_xor_b32 s56, s55, 155648
    buffer_load_dwordx4 v[164:167], v4, s[8:11], s56 offen nt
    v_and_b32_dpp v24, v42, v8 row_newbcast:0 row_mask:0xf bank_mask:0xf
    v_and_b32_dpp v25, v42, v9 row_newbcast:0 row_mask:0xf bank_mask:0xf
    v_and_b32_dpp v26, v42, v10 row_newbcast:0 row_mask:0xf bank_mask:0xf
    v_and_b32_dpp v27, v42, v11 row_newbcast:0 row_mask:0xf bank_mask:0xf
    s_nop 1
    v_mfma_f32_16x16x32_bf16 v[20:23], v[24:27], v[152:155], v[20:23]
    s_waitcnt vmcnt(2)
    s_xor_b32 s56, s55, 196608
    buffer_load_dwordx4 v[56:59], v4, s[8:11], s56 offen nt
    v_and_b32_dpp v28, v42, v8 row_newbcast:8 row_mask:0xf bank_mask:0xf
    v_and_b32_dpp v29, v42, v9 row_newbcast:8 row_mask:0xf bank_mask:0xf
    v_and_b32_dpp v30, v42, v10 row_newbcast:8 row_mask:0xf bank_mask:0xf
    v_and_b32_dpp v31, v42, v11 row_newbcast:8 row_mask:0xf bank_mask:0xf
    s_nop 1
    v_mfma_f32_16x16x32_bf16 v[20:23], v[28:31], v[156:159], v[20:23]
    s_waitcnt vmcnt(2)
    s_xor_b32 s56, s55, 204800
    buffer_load_dwordx4 v[60:63], v4, s[8:11], s56 offen nt
    v_and_b32_dpp v24, v42, v8 row_newbcast:4 row_mask:0xf bank_mask:0xf
    v_and_b32_dpp v25, v42, v9 row_newbcast:4 row_mask:0xf bank_mask:0xf
    v_and_b32_dpp v26, v42, v10 row_newbcast:4 row_mask:0xf bank_mask:0xf
    v_and_b32_dpp v27, v42, v11 row_newbcast:4 row_mask:0xf bank_mask:0xf
    s_nop 1
    v_mfma_f32_16x16x32_bf16 v[20:23], v[24:27], v[160:163], v[20:23]
    s_waitcnt vmcnt(2)
    s_xor_b32 s56, s55, 212992
    buffer_load_dwordx4 v[64:67], v4, s[8:11], s56 offen nt
    v_and_b32_dpp v28, v42, v8 row_newbcast:12 row_mask:0xf bank_mask:0xf
    v_and_b32_dpp v29, v42, v9 row_newbcast:12 row_mask:0xf bank_mask:0xf
    v_and_b32_dpp v30, v42, v10 row_newbcast:12 row_mask:0xf bank_mask:0xf
    v_and_b32_dpp v31, v42, v11 row_newbcast:12 row_mask:0xf bank_mask:0xf
    s_nop 1
    v_mfma_f32_16x16x32_bf16 v[20:23], v[28:31], v[164:167], v[20:23]
    s_waitcnt vmcnt(2)
    s_xor_b32 s56, s55, 221184
    buffer_load_dwordx4 v[68:71], v4, s[8:11], s56 offen nt
    v_and_b32_dpp v24, v43, v8 row_newbcast:0 row_mask:0xf bank_mask:0xf
    v_and_b32_dpp v25, v43, v9 row_newbcast:0 row_mask:0xf bank_mask:0xf
    v_and_b32_dpp v26, v43, v10 row_newbcast:0 row_mask:0xf bank_mask:0xf
    v_and_b32_dpp v27, v43, v11 row_newbcast:0 row_mask:0xf bank_mask:0xf
    s_nop 1
    v_mfma_f32_16x16x32_bf16 v[20:23], v[24:27], v[56:59], v[20:23]
    s_waitcnt vmcnt(2)
    s_xor_b32 s56, s55, 262144
    buffer_load_dwordx4 v[72:75], v4, s[8:11], s56 offen nt
    v_and_b32_dpp v28, v43, v8 row_newbcast:8 row_mask:0xf bank_mask:0xf
    v_and_b32_dpp v29, v43, v9 row_newbcast:8 row_mask:0xf bank_mask:0xf
    v_and_b32_dpp v30, v43, v10 row_newbcast:8 row_mask:0xf bank_mask:0xf
    v_and_b32_dpp v31, v43, v11 row_newbcast:8 row_mask:0xf bank_mask:0xf
    s_nop 1
    v_mfma_f32_16x16x32_bf16 v[20:23], v[28:31], v[60:63], v[20:23]
    s_waitcnt vmcnt(2)
    s_xor_b32 s56, s55, 270336
    buffer_load_dwordx4 v[76:79], v4, s[8:11], s56 offen nt
    v_and_b32_dpp v24, v43, v8 row_newbcast:4 row_mask:0xf bank_mask:0xf
    v_and_b32_dpp v25, v43, v9 row_newbcast:4 row_mask:0xf bank_mask:0xf
    v_and_b32_dpp v26, v43, v10 row_newbcast:4 row_mask:0xf bank_mask:0xf
    v_and_b32_dpp v27, v43, v11 row_newbcast:4 row_mask:0xf bank_mask:0xf
    s_nop 1
    v_mfma_f32_16x16x32_bf16 v[20:23], v[24:27], v[64:67], v[20:23]
    s_waitcnt vmcnt(2)
    s_xor_b32 s56, s55, 278528
    buffer_load_dwordx4 v[80:83], v4, s[8:11], s56 offen nt
    v_and_b32_dpp v28, v43, v8 row_newbcast:12 row_mask:0xf bank_mask:0xf
    v_and_b32_dpp v29, v43, v9 row_newbcast:12 row_mask:0xf bank_mask:0xf
    v_and_b32_dpp v30, v43, v10 row_newbcast:12 row_mask:0xf bank_mask:0xf
    v_and_b32_dpp v31, v43, v11 row_newbcast:12 row_mask:0xf bank_mask:0xf
    s_nop 1
    v_mfma_f32_16x16x32_bf16 v[20:23], v[28:31], v[68:71], v[20:23]
    s_waitcnt vmcnt(2)
    s_xor_b32 s56, s55, 286720
    buffer_load_dwordx4 v[84:87], v4, s[8:11], s56 offen nt
    v_and_b32_dpp v24, v44, v8 row_newbcast:0 row_mask:0xf bank_mask:0xf
    v_and_b32_dpp v25, v44, v9 row_newbcast:0 row_mask:0xf bank_mask:0xf
    v_and_b32_dpp v26, v44, v10 row_newbcast:0 row_mask:0xf bank_mask:0xf
    v_and_b32_dpp v27, v44, v11 row_newbcast:0 row_mask:0xf bank_mask:0xf
    s_nop 1
    v_mfma_f32_16x16x32_bf16 v[20:23], v[24:27], v[72:75], v[20:23]
    s_waitcnt vmcnt(2)
    s_xor_b32 s56, s55, 327680
    buffer_load_dwordx4 v[88:91], v4, s[8:11], s56 offen nt
    v_and_b32_dpp v28, v44, v8 row_newbcast:8 row_mask:0xf bank_mask:0xf
    v_and_b32_dpp v29, v44, v9 row_newbcast:8 row_mask:0xf bank_mask:0xf
    v_and_b32_dpp v30, v44, v10 row_newbcast:8 row_mask:0xf bank_mask:0xf
    v_and_b32_dpp v31, v44, v11 row_newbcast:8 row_mask:0xf bank_mask:0xf
    s_nop 1
    v_mfma_f32_16x16x32_bf16 v[20:23], v[28:31], v[76:79], v[20:23]
    s_waitcnt vmcnt(2)
    s_xor_b32 s56, s55, 335872
    buffer_load_dwordx4 v[92:95], v4, s[8:11], s56 offen nt
    v_and_b32_dpp v24, v44, v8 row_newbcast:4 row_mask:0xf bank_mask:0xf
    v_and_b32_dpp v25, v44, v9 row_newbcast:4 row_mask:0xf bank_mask:0xf
    v_and_b32_dpp v26, v44, v10 row_newbcast:4 row_mask:0xf bank_mask:0xf
    v_and_b32_dpp v27, v44, v11 row_newbcast:4 row_mask:0xf bank_mask:0xf
    s_nop 1
    v_mfma_f32_16x16x32_bf16 v[20:23], v[24:27], v[80:83], v[20:23]
    s_waitcnt vmcnt(2)
    s_xor_b32 s56, s55, 344064
    buffer_load_dwordx4 v[96:99], v4, s[8:11], s56 offen nt
    v_and_b32_dpp v28, v44, v8 row_newbcast:12 row_mask:0xf bank_mask:0xf
    v_and_b32_dpp v29, v44, v9 row_newbcast:12 row_mask:0xf bank_mask:0xf
    v_and_b32_dpp v30, v44, v10 row_newbcast:12 row_mask:0xf bank_mask:0xf
    v_and_b32_dpp v31, v44, v11 row_newbcast:12 row_mask:0xf bank_mask:0xf
    s_nop 1
    v_mfma_f32_16x16x32_bf16 v[20:23], v[28:31], v[84:87], v[20:23]
    s_waitcnt vmcnt(2)
    s_xor_b32 s56, s55, 352256
    buffer_load_dwordx4 v[100:103], v4, s[8:11], s56 offen nt
    v_and_b32_dpp v24, v45, v8 row_newbcast:0 row_mask:0xf bank_mask:0xf
    v_and_b32_dpp v25, v45, v9 row_newbcast:0 row_mask:0xf bank_mask:0xf
    v_and_b32_dpp v26, v45, v10 row_newbcast:0 row_mask:0xf bank_mask:0xf
    v_and_b32_dpp v27, v45, v11 row_newbcast:0 row_mask:0xf bank_mask:0xf
    s_nop 1
    v_mfma_f32_16x16x32_bf16 v[20:23], v[24:27], v[88:91], v[20:23]
    s_waitcnt vmcnt(2)
    s_xor_b32 s56, s55, 393216
    buffer_load_dwordx4 v[104:107], v4, s[8:11], s56 offen nt
    v_and_b32_dpp v28, v45, v8 row_newbcast:8 row_mask:0xf bank_mask:0xf
    v_and_b32_dpp v29, v45, v9 row_newbcast:8 row_mask:0xf bank_mask:0xf
    v_and_b32_dpp v30, v45, v10 row_newbcast:8 row_mask:0xf bank_mask:0xf
    v_and_b32_dpp v31, v45, v11 row_newbcast:8 row_mask:0xf bank_mask:0xf
    s_nop 1
    v_mfma_f32_16x16x32_bf16 v[20:23], v[28:31], v[92:95], v[20:23]
    s_waitcnt vmcnt(2)
    s_xor_b32 s56, s55, 401408
    buffer_load_dwordx4 v[108:111], v4, s[8:11], s56 offen nt
    v_and_b32_dpp v24, v45, v8 row_newbcast:4 row_mask:0xf bank_mask:0xf
    v_and_b32_dpp v25, v45, v9 row_newbcast:4 row_mask:0xf bank_mask:0xf
    v_and_b32_dpp v26, v45, v10 row_newbcast:4 row_mask:0xf bank_mask:0xf
    v_and_b32_dpp v27, v45, v11 row_newbcast:4 row_mask:0xf bank_mask:0xf
    s_nop 1
    v_mfma_f32_16x16x32_bf16 v[20:23], v[24:27], v[96:99], v[20:23]
    s_waitcnt vmcnt(2)
    s_xor_b32 s56, s55, 409600
    buffer_load_dwordx4 v[112:115], v4, s[8:11], s56 offen nt
    v_and_b32_dpp v28, v45, v8 row_newbcast:12 row_mask:0xf bank_mask:0xf
    v_and_b32_dpp v29, v45, v9 row_newbcast:12 row_mask:0xf bank_mask:0xf
    v_and_b32_dpp v30, v45, v10 row_newbcast:12 row_mask:0xf bank_mask:0xf
    v_and_b32_dpp v31, v45, v11 row_newbcast:12 row_mask:0xf bank_mask:0xf
    s_nop 1
    v_mfma_f32_16x16x32_bf16 v[20:23], v[28:31], v[100:103], v[20:23]
    s_waitcnt vmcnt(2)
    s_xor_b32 s56, s55, 417792
    buffer_load_dwordx4 v[116:119], v4, s[8:11], s56 offen nt
    v_and_b32_dpp v24, v46, v8 row_newbcast:0 row_mask:0xf bank_mask:0xf
    v_and_b32_dpp v25, v46, v9 row_newbcast:0 row_mask:0xf bank_mask:0xf
    v_and_b32_dpp v26, v46, v10 row_newbcast:0 row_mask:0xf bank_mask:0xf
    v_and_b32_dpp v27, v46, v11 row_newbcast:0 row_mask:0xf bank_mask:0xf
    s_nop 1
    v_mfma_f32_16x16x32_bf16 v[20:23], v[24:27], v[104:107], v[20:23]
    s_waitcnt vmcnt(2)
    s_xor_b32 s56, s55, 458752
    buffer_load_dwordx4 v[120:123], v4, s[8:11], s56 offen nt
    v_and_b32_dpp v28, v46, v8 row_newbcast:8 row_mask:0xf bank_mask:0xf
    v_and_b32_dpp v29, v46, v9 row_newbcast:8 row_mask:0xf bank_mask:0xf
    v_and_b32_dpp v30, v46, v10 row_newbcast:8 row_mask:0xf bank_mask:0xf
    v_and_b32_dpp v31, v46, v11 row_newbcast:8 row_mask:0xf bank_mask:0xf
    s_nop 1
    v_mfma_f32_16x16x32_bf16 v[20:23], v[28:31], v[108:111], v[20:23]
    s_waitcnt vmcnt(2)
    s_xor_b32 s56, s55, 466944
    buffer_load_dwordx4 v[124:127], v4, s[8:11], s56 offen nt
    v_and_b32_dpp v24, v46, v8 row_newbcast:4 row_mask:0xf bank_mask:0xf
    v_and_b32_dpp v25, v46, v9 row_newbcast:4 row_mask:0xf bank_mask:0xf
    v_and_b32_dpp v26, v46, v10 row_newbcast:4 row_mask:0xf bank_mask:0xf
    v_and_b32_dpp v27, v46, v11 row_newbcast:4 row_mask:0xf bank_mask:0xf
    s_nop 1
    v_mfma_f32_16x16x32_bf16 v[20:23], v[24:27], v[112:115], v[20:23]
    s_waitcnt vmcnt(2)
    s_xor_b32 s56, s55, 475136
    buffer_load_dwordx4 v[128:131], v4, s[8:11], s56 offen nt
    v_and_b32_dpp v28, v46, v8 row_newbcast:12 row_mask:0xf bank_mask:0xf
    v_and_b32_dpp v29, v46, v9 row_newbcast:12 row_mask:0xf bank_mask:0xf
    v_and_b32_dpp v30, v46, v10 row_newbcast:12 row_mask:0xf bank_mask:0xf
    v_and_b32_dpp v31, v46, v11 row_newbcast:12 row_mask:0xf bank_mask:0xf
    s_nop 1
    v_mfma_f32_16x16x32_bf16 v[20:23], v[28:31], v[116:119], v[20:23]
    s_waitcnt vmcnt(2)
    s_xor_b32 s56, s55, 483328
    buffer_load_dwordx4 v[132:135], v4, s[8:11], s56 offen nt
    v_and_b32_dpp v24, v47, v8 row_newbcast:0 row_mask:0xf bank_mask:0xf
    v_and_b32_dpp v25, v47, v9 row_newbcast:0 row_mask:0xf bank_mask:0xf
    v_and_b32_dpp v26, v47, v10 row_newbcast:0 row_mask:0xf bank_mask:0xf
    v_and_b32_dpp v27, v47, v11 row_newbcast:0 row_mask:0xf bank_mask:0xf
    s_nop 1
    v_mfma_f32_16x16x32_bf16 v[20:23], v[24:27], v[120:123], v[20:23]
    s_waitcnt vmcnt(2)
    s_xor_b32 s56, s55, 524288
    buffer_load_dwordx4 v[136:139], v4, s[8:11], s56 offen nt
    v_and_b32_dpp v28, v47, v8 row_newbcast:8 row_mask:0xf bank_mask:0xf
    v_and_b32_dpp v29, v47, v9 row_newbcast:8 row_mask:0xf bank_mask:0xf
    v_and_b32_dpp v30, v47, v10 row_newbcast:8 row_mask:0xf bank_mask:0xf
    v_and_b32_dpp v31, v47, v11 row_newbcast:8 row_mask:0xf bank_mask:0xf
    s_nop 1
    v_mfma_f32_16x16x32_bf16 v[20:23], v[28:31], v[124:127], v[20:23]
    s_waitcnt vmcnt(2)
    s_xor_b32 s56, s55, 532480
    buffer_load_dwordx4 v[140:143], v4, s[8:11], s56 offen nt
    v_and_b32_dpp v24, v47, v8 row_newbcast:4 row_mask:0xf bank_mask:0xf
    v_and_b32_dpp v25, v47, v9 row_newbcast:4 row_mask:0xf bank_mask:0xf
    v_and_b32_dpp v26, v47, v10 row_newbcast:4 row_mask:0xf bank_mask:0xf
    v_and_b32_dpp v27, v47, v11 row_newbcast:4 row_mask:0xf bank_mask:0xf
    s_nop 1
    v_mfma_f32_16x16x32_bf16 v[20:23], v[24:27], v[128:131], v[20:23]
    s_waitcnt vmcnt(2)
    s_xor_b32 s56, s55, 540672
    buffer_load_dwordx4 v[144:147], v4, s[8:11], s56 offen nt
    v_and_b32_dpp v28, v47, v8 row_newbcast:12 row_mask:0xf bank_mask:0xf
    v_and_b32_dpp v29, v47, v9 row_newbcast:12 row_mask:0xf bank_mask:0xf
    v_and_b32_dpp v30, v47, v10 row_newbcast:12 row_mask:0xf bank_mask:0xf
    v_and_b32_dpp v31, v47, v11 row_newbcast:12 row_mask:0xf bank_mask:0xf
    s_nop 1
    v_mfma_f32_16x16x32_bf16 v[20:23], v[28:31], v[132:135], v[20:23]
    s_waitcnt vmcnt(2)
    s_xor_b32 s56, s55, 548864
    buffer_load_dwordx4 v[148:151], v4, s[8:11], s56 offen nt
    v_and_b32_dpp v24, v48, v8 row_newbcast:0 row_mask:0xf bank_mask:0xf
    v_and_b32_dpp v25, v48, v9 row_newbcast:0 row_mask:0xf bank_mask:0xf
    v_and_b32_dpp v26, v48, v10 row_newbcast:0 row_mask:0xf bank_mask:0xf
    v_and_b32_dpp v27, v48, v11 row_newbcast:0 row_mask:0xf bank_mask:0xf
    s_nop 1
    v_mfma_f32_16x16x32_bf16 v[20:23], v[24:27], v[136:139], v[20:23]
    s_waitcnt vmcnt(2)
    s_xor_b32 s56, s55, 589824
    buffer_load_dwordx4 v[152:155], v4, s[8:11], s56 offen nt
    v_and_b32_dpp v28, v48, v8 row_newbcast:8 row_mask:0xf bank_mask:0xf
    v_and_b32_dpp v29, v48, v9 row_newbcast:8 row_mask:0xf bank_mask:0xf
    v_and_b32_dpp v30, v48, v10 row_newbcast:8 row_mask:0xf bank_mask:0xf
    v_and_b32_dpp v31, v48, v11 row_newbcast:8 row_mask:0xf bank_mask:0xf
    s_nop 1
    v_mfma_f32_16x16x32_bf16 v[20:23], v[28:31], v[140:143], v[20:23]
    s_waitcnt vmcnt(2)
    s_xor_b32 s56, s55, 598016
    buffer_load_dwordx4 v[156:159], v4, s[8:11], s56 offen nt
    v_and_b32_dpp v24, v48, v8 row_newbcast:4 row_mask:0xf bank_mask:0xf
    v_and_b32_dpp v25, v48, v9 row_newbcast:4 row_mask:0xf bank_mask:0xf
    v_and_b32_dpp v26, v48, v10 row_newbcast:4 row_mask:0xf bank_mask:0xf
    v_and_b32_dpp v27, v48, v11 row_newbcast:4 row_mask:0xf bank_mask:0xf
    s_nop 1
    v_mfma_f32_16x16x32_bf16 v[20:23], v[24:27], v[144:147], v[20:23]
    s_waitcnt vmcnt(2)
    s_xor_b32 s56, s55, 606208
    buffer_load_dwordx4 v[160:163], v4, s[8:11], s56 offen nt
    v_and_b32_dpp v28, v48, v8 row_newbcast:12 row_mask:0xf bank_mask:0xf
    v_and_b32_dpp v29, v48, v9 row_newbcast:12 row_mask:0xf bank_mask:0xf
    v_and_b32_dpp v30, v48, v10 row_newbcast:12 row_mask:0xf bank_mask:0xf
    v_and_b32_dpp v31, v48, v11 row_newbcast:12 row_mask:0xf bank_mask:0xf
    s_nop 1
    v_mfma_f32_16x16x32_bf16 v[20:23], v[28:31], v[148:151], v[20:23]
    s_waitcnt vmcnt(2)
    s_xor_b32 s56, s55, 614400
    buffer_load_dwordx4 v[164:167], v4, s[8:11], s56 offen nt
    v_and_b32_dpp v24, v49, v8 row_newbcast:0 row_mask:0xf bank_mask:0xf
    v_and_b32_dpp v25, v49, v9 row_newbcast:0 row_mask:0xf bank_mask:0xf
    v_and_b32_dpp v26, v49, v10 row_newbcast:0 row_mask:0xf bank_mask:0xf
    v_and_b32_dpp v27, v49, v11 row_newbcast:0 row_mask:0xf bank_mask:0xf
    s_nop 1
    v_mfma_f32_16x16x32_bf16 v[20:23], v[24:27], v[152:155], v[20:23]
    s_waitcnt vmcnt(2)
    s_xor_b32 s56, s55, 655360
    buffer_load_dwordx4 v[56:59], v4, s[8:11], s56 offen nt
    v_and_b32_dpp v28, v49, v8 row_newbcast:8 row_mask:0xf bank_mask:0xf
    v_and_b32_dpp v29, v49, v9 row_newbcast:8 row_mask:0xf bank_mask:0xf
    v_and_b32_dpp v30, v49, v10 row_newbcast:8 row_mask:0xf bank_mask:0xf
    v_and_b32_dpp v31, v49, v11 row_newbcast:8 row_mask:0xf bank_mask:0xf
    s_nop 1
    v_mfma_f32_16x16x32_bf16 v[20:23], v[28:31], v[156:159], v[20:23]
    s_waitcnt vmcnt(2)
    s_xor_b32 s56, s55, 663552
    buffer_load_dwordx4 v[60:63], v4, s[8:11], s56 offen nt
    v_and_b32_dpp v24, v49, v8 row_newbcast:4 row_mask:0xf bank_mask:0xf
    v_and_b32_dpp v25, v49, v9 row_newbcast:4 row_mask:0xf bank_mask:0xf
    v_and_b32_dpp v26, v49, v10 row_newbcast:4 row_mask:0xf bank_mask:0xf
    v_and_b32_dpp v27, v49, v11 row_newbcast:4 row_mask:0xf bank_mask:0xf
    s_nop 1
    v_mfma_f32_16x16x32_bf16 v[20:23], v[24:27], v[160:163], v[20:23]
    s_waitcnt vmcnt(2)
    s_xor_b32 s56, s55, 671744
    buffer_load_dwordx4 v[64:67], v4, s[8:11], s56 offen nt
    v_and_b32_dpp v28, v49, v8 row_newbcast:12 row_mask:0xf bank_mask:0xf
    v_and_b32_dpp v29, v49, v9 row_newbcast:12 row_mask:0xf bank_mask:0xf
    v_and_b32_dpp v30, v49, v10 row_newbcast:12 row_mask:0xf bank_mask:0xf
    v_and_b32_dpp v31, v49, v11 row_newbcast:12 row_mask:0xf bank_mask:0xf
    s_nop 1
    v_mfma_f32_16x16x32_bf16 v[20:23], v[28:31], v[164:167], v[20:23]
    s_waitcnt vmcnt(2)
    s_xor_b32 s56, s55, 679936
    buffer_load_dwordx4 v[68:71], v4, s[8:11], s56 offen nt
    v_and_b32_dpp v24, v50, v8 row_newbcast:0 row_mask:0xf bank_mask:0xf
    v_and_b32_dpp v25, v50, v9 row_newbcast:0 row_mask:0xf bank_mask:0xf
    v_and_b32_dpp v26, v50, v10 row_newbcast:0 row_mask:0xf bank_mask:0xf
    v_and_b32_dpp v27, v50, v11 row_newbcast:0 row_mask:0xf bank_mask:0xf
    s_nop 1
    v_mfma_f32_16x16x32_bf16 v[20:23], v[24:27], v[56:59], v[20:23]
    s_waitcnt vmcnt(2)
    s_xor_b32 s56, s55, 720896
    buffer_load_dwordx4 v[72:75], v4, s[8:11], s56 offen nt
    ds_write_b32 v0, v0 offset:20
    v_and_b32_dpp v28, v50, v8 row_newbcast:8 row_mask:0xf bank_mask:0xf
    v_and_b32_dpp v29, v50, v9 row_newbcast:8 row_mask:0xf bank_mask:0xf
    v_and_b32_dpp v30, v50, v10 row_newbcast:8 row_mask:0xf bank_mask:0xf
    v_and_b32_dpp v31, v50, v11 row_newbcast:8 row_mask:0xf bank_mask:0xf
    s_nop 1
    v_mfma_f32_16x16x32_bf16 v[20:23], v[28:31], v[60:63], v[20:23]
    s_waitcnt vmcnt(2)
    s_xor_b32 s56, s55, 729088
    buffer_load_dwordx4 v[76:79], v4, s[8:11], s56 offen nt
    v_and_b32_dpp v24, v50, v8 row_newbcast:4 row_mask:0xf bank_mask:0xf
    v_and_b32_dpp v25, v50, v9 row_newbcast:4 row_mask:0xf bank_mask:0xf
    v_and_b32_dpp v26, v50, v10 row_newbcast:4 row_mask:0xf bank_mask:0xf
    v_and_b32_dpp v27, v50, v11 row_newbcast:4 row_mask:0xf bank_mask:0xf
    s_nop 1
    v_mfma_f32_16x16x32_bf16 v[20:23], v[24:27], v[64:67], v[20:23]
    s_waitcnt vmcnt(2)
    s_xor_b32 s56, s55, 737280
    buffer_load_dwordx4 v[80:83], v4, s[8:11], s56 offen nt
    v_and_b32_dpp v28, v50, v8 row_newbcast:12 row_mask:0xf bank_mask:0xf
    v_and_b32_dpp v29, v50, v9 row_newbcast:12 row_mask:0xf bank_mask:0xf
    v_and_b32_dpp v30, v50, v10 row_newbcast:12 row_mask:0xf bank_mask:0xf
    v_and_b32_dpp v31, v50, v11 row_newbcast:12 row_mask:0xf bank_mask:0xf
    s_nop 1
    v_mfma_f32_16x16x32_bf16 v[20:23], v[28:31], v[68:71], v[20:23]
    s_waitcnt vmcnt(2)
    s_xor_b32 s56, s55, 745472
    buffer_load_dwordx4 v[84:87], v4, s[8:11], s56 offen nt
    v_and_b32_dpp v24, v51, v8 row_newbcast:0 row_mask:0xf bank_mask:0xf
    v_and_b32_dpp v25, v51, v9 row_newbcast:0 row_mask:0xf bank_mask:0xf
    v_and_b32_dpp v26, v51, v10 row_newbcast:0 row_mask:0xf bank_mask:0xf
    v_and_b32_dpp v27, v51, v11 row_newbcast:0 row_mask:0xf bank_mask:0xf
    s_nop 1
    v_mfma_f32_16x16x32_bf16 v[20:23], v[24:27], v[72:75], v[20:23]
    s_waitcnt vmcnt(2)
    s_xor_b32 s56, s55, 786432
    buffer_load_dwordx4 v[88:91], v4, s[8:11], s56 offen nt
    v_and_b32_dpp v28, v51, v8 row_newbcast:8 row_mask:0xf bank_mask:0xf
    v_and_b32_dpp v29, v51, v9 row_newbcast:8 row_mask:0xf bank_mask:0xf
    v_and_b32_dpp v30, v51, v10 row_newbcast:8 row_mask:0xf bank_mask:0xf
    v_and_b32_dpp v31, v51, v11 row_newbcast:8 row_mask:0xf bank_mask:0xf
    s_nop 1
    v_mfma_f32_16x16x32_bf16 v[20:23], v[28:31], v[76:79], v[20:23]
    s_waitcnt vmcnt(2)
    s_xor_b32 s56, s55, 794624
    buffer_load_dwordx4 v[92:95], v4, s[8:11], s56 offen nt
    v_and_b32_dpp v24, v51, v8 row_newbcast:4 row_mask:0xf bank_mask:0xf
    v_and_b32_dpp v25, v51, v9 row_newbcast:4 row_mask:0xf bank_mask:0xf
    v_and_b32_dpp v26, v51, v10 row_newbcast:4 row_mask:0xf bank_mask:0xf
    v_and_b32_dpp v27, v51, v11 row_newbcast:4 row_mask:0xf bank_mask:0xf
    s_nop 1
    v_mfma_f32_16x16x32_bf16 v[20:23], v[24:27], v[80:83], v[20:23]
    s_waitcnt vmcnt(2)
    s_xor_b32 s56, s55, 802816
    buffer_load_dwordx4 v[96:99], v4, s[8:11], s56 offen nt
    v_and_b32_dpp v28, v51, v8 row_newbcast:12 row_mask:0xf bank_mask:0xf
    v_and_b32_dpp v29, v51, v9 row_newbcast:12 row_mask:0xf bank_mask:0xf
    v_and_b32_dpp v30, v51, v10 row_newbcast:12 row_mask:0xf bank_mask:0xf
    v_and_b32_dpp v31, v51, v11 row_newbcast:12 row_mask:0xf bank_mask:0xf
    s_nop 1
    v_mfma_f32_16x16x32_bf16 v[20:23], v[28:31], v[84:87], v[20:23]
    s_waitcnt vmcnt(2)
    s_xor_b32 s56, s55, 811008
    buffer_load_dwordx4 v[100:103], v4, s[8:11], s56 offen nt
    v_and_b32_dpp v24, v52, v8 row_newbcast:0 row_mask:0xf bank_mask:0xf
    v_and_b32_dpp v25, v52, v9 row_newbcast:0 row_mask:0xf bank_mask:0xf
    v_and_b32_dpp v26, v52, v10 row_newbcast:0 row_mask:0xf bank_mask:0xf
    v_and_b32_dpp v27, v52, v11 row_newbcast:0 row_mask:0xf bank_mask:0xf
    s_nop 1
    v_mfma_f32_16x16x32_bf16 v[20:23], v[24:27], v[88:91], v[20:23]
    s_waitcnt vmcnt(2)
    s_xor_b32 s56, s55, 851968
    buffer_load_dwordx4 v[104:107], v4, s[8:11], s56 offen nt
    v_and_b32_dpp v28, v52, v8 row_newbcast:8 row_mask:0xf bank_mask:0xf
    v_and_b32_dpp v29, v52, v9 row_newbcast:8 row_mask:0xf bank_mask:0xf
    v_and_b32_dpp v30, v52, v10 row_newbcast:8 row_mask:0xf bank_mask:0xf
    v_and_b32_dpp v31, v52, v11 row_newbcast:8 row_mask:0xf bank_mask:0xf
    s_nop 1
    v_mfma_f32_16x16x32_bf16 v[20:23], v[28:31], v[92:95], v[20:23]
    s_waitcnt vmcnt(2)
    s_xor_b32 s56, s55, 860160
    buffer_load_dwordx4 v[108:111], v4, s[8:11], s56 offen nt
    v_and_b32_dpp v24, v52, v8 row_newbcast:4 row_mask:0xf bank_mask:0xf
    v_and_b32_dpp v25, v52, v9 row_newbcast:4 row_mask:0xf bank_mask:0xf
    v_and_b32_dpp v26, v52, v10 row_newbcast:4 row_mask:0xf bank_mask:0xf
    v_and_b32_dpp v27, v52, v11 row_newbcast:4 row_mask:0xf bank_mask:0xf
    s_nop 1
    v_mfma_f32_16x16x32_bf16 v[20:23], v[24:27], v[96:99], v[20:23]
    s_waitcnt vmcnt(2)
    s_xor_b32 s56, s55, 868352
    buffer_load_dwordx4 v[112:115], v4, s[8:11], s56 offen nt
    v_and_b32_dpp v28, v52, v8 row_newbcast:12 row_mask:0xf bank_mask:0xf
    v_and_b32_dpp v29, v52, v9 row_newbcast:12 row_mask:0xf bank_mask:0xf
    v_and_b32_dpp v30, v52, v10 row_newbcast:12 row_mask:0xf bank_mask:0xf
    v_and_b32_dpp v31, v52, v11 row_newbcast:12 row_mask:0xf bank_mask:0xf
    s_nop 1
    v_mfma_f32_16x16x32_bf16 v[20:23], v[28:31], v[100:103], v[20:23]
    s_waitcnt vmcnt(2)
    s_xor_b32 s56, s55, 876544
    buffer_load_dwordx4 v[116:119], v4, s[8:11], s56 offen nt
    v_and_b32_dpp v24, v53, v8 row_newbcast:0 row_mask:0xf bank_mask:0xf
    v_and_b32_dpp v25, v53, v9 row_newbcast:0 row_mask:0xf bank_mask:0xf
    v_and_b32_dpp v26, v53, v10 row_newbcast:0 row_mask:0xf bank_mask:0xf
    v_and_b32_dpp v27, v53, v11 row_newbcast:0 row_mask:0xf bank_mask:0xf
    s_nop 1
    v_mfma_f32_16x16x32_bf16 v[20:23], v[24:27], v[104:107], v[20:23]
    s_waitcnt vmcnt(2)
    s_xor_b32 s56, s55, 917504
    buffer_load_dwordx4 v[120:123], v4, s[8:11], s56 offen nt
    v_and_b32_dpp v28, v53, v8 row_newbcast:8 row_mask:0xf bank_mask:0xf
    v_and_b32_dpp v29, v53, v9 row_newbcast:8 row_mask:0xf bank_mask:0xf
    v_and_b32_dpp v30, v53, v10 row_newbcast:8 row_mask:0xf bank_mask:0xf
    v_and_b32_dpp v31, v53, v11 row_newbcast:8 row_mask:0xf bank_mask:0xf
    s_nop 1
    v_mfma_f32_16x16x32_bf16 v[20:23], v[28:31], v[108:111], v[20:23]
    s_waitcnt vmcnt(2)
    s_xor_b32 s56, s55, 925696
    buffer_load_dwordx4 v[124:127], v4, s[8:11], s56 offen nt
    v_and_b32_dpp v24, v53, v8 row_newbcast:4 row_mask:0xf bank_mask:0xf
    v_and_b32_dpp v25, v53, v9 row_newbcast:4 row_mask:0xf bank_mask:0xf
    v_and_b32_dpp v26, v53, v10 row_newbcast:4 row_mask:0xf bank_mask:0xf
    v_and_b32_dpp v27, v53, v11 row_newbcast:4 row_mask:0xf bank_mask:0xf
    s_nop 1
    v_mfma_f32_16x16x32_bf16 v[20:23], v[24:27], v[112:115], v[20:23]
    s_waitcnt vmcnt(2)
    s_xor_b32 s56, s55, 933888
    buffer_load_dwordx4 v[128:131], v4, s[8:11], s56 offen nt
    v_and_b32_dpp v28, v53, v8 row_newbcast:12 row_mask:0xf bank_mask:0xf
    v_and_b32_dpp v29, v53, v9 row_newbcast:12 row_mask:0xf bank_mask:0xf
    v_and_b32_dpp v30, v53, v10 row_newbcast:12 row_mask:0xf bank_mask:0xf
    v_and_b32_dpp v31, v53, v11 row_newbcast:12 row_mask:0xf bank_mask:0xf
    s_nop 1
    v_mfma_f32_16x16x32_bf16 v[20:23], v[28:31], v[116:119], v[20:23]
    s_waitcnt vmcnt(2)
    s_xor_b32 s56, s55, 942080
    buffer_load_dwordx4 v[132:135], v4, s[8:11], s56 offen nt
    v_and_b32_dpp v24, v54, v8 row_newbcast:0 row_mask:0xf bank_mask:0xf
    v_and_b32_dpp v25, v54, v9 row_newbcast:0 row_mask:0xf bank_mask:0xf
    v_and_b32_dpp v26, v54, v10 row_newbcast:0 row_mask:0xf bank_mask:0xf
    v_and_b32_dpp v27, v54, v11 row_newbcast:0 row_mask:0xf bank_mask:0xf
    s_nop 1
    v_mfma_f32_16x16x32_bf16 v[20:23], v[24:27], v[120:123], v[20:23]
    s_waitcnt vmcnt(2)
    s_xor_b32 s56, s55, 983040
    buffer_load_dwordx4 v[136:139], v4, s[8:11], s56 offen nt
    v_and_b32_dpp v28, v54, v8 row_newbcast:8 row_mask:0xf bank_mask:0xf
    v_and_b32_dpp v29, v54, v9 row_newbcast:8 row_mask:0xf bank_mask:0xf
    v_and_b32_dpp v30, v54, v10 row_newbcast:8 row_mask:0xf bank_mask:0xf
    v_and_b32_dpp v31, v54, v11 row_newbcast:8 row_mask:0xf bank_mask:0xf
    s_nop 1
    v_mfma_f32_16x16x32_bf16 v[20:23], v[28:31], v[124:127], v[20:23]
    s_waitcnt vmcnt(2)
    s_xor_b32 s56, s55, 991232
    buffer_load_dwordx4 v[140:143], v4, s[8:11], s56 offen nt
    v_and_b32_dpp v24, v54, v8 row_newbcast:4 row_mask:0xf bank_mask:0xf
    v_and_b32_dpp v25, v54, v9 row_newbcast:4 row_mask:0xf bank_mask:0xf
    v_and_b32_dpp v26, v54, v10 row_newbcast:4 row_mask:0xf bank_mask:0xf
    v_and_b32_dpp v27, v54, v11 row_newbcast:4 row_mask:0xf bank_mask:0xf
    s_nop 1
    v_mfma_f32_16x16x32_bf16 v[20:23], v[24:27], v[128:131], v[20:23]
    s_waitcnt vmcnt(2)
    s_xor_b32 s56, s55, 999424
    buffer_load_dwordx4 v[144:147], v4, s[8:11], s56 offen nt
    v_and_b32_dpp v28, v54, v8 row_newbcast:12 row_mask:0xf bank_mask:0xf
    v_and_b32_dpp v29, v54, v9 row_newbcast:12 row_mask:0xf bank_mask:0xf
    v_and_b32_dpp v30, v54, v10 row_newbcast:12 row_mask:0xf bank_mask:0xf
    v_and_b32_dpp v31, v54, v11 row_newbcast:12 row_mask:0xf bank_mask:0xf
    s_nop 1
    v_mfma_f32_16x16x32_bf16 v[20:23], v[28:31], v[132:135], v[20:23]
    s_waitcnt vmcnt(2)
    s_xor_b32 s56, s55, 1007616
    buffer_load_dwordx4 v[148:151], v4, s[8:11], s56 offen nt
    v_and_b32_dpp v24, v55, v8 row_newbcast:0 row_mask:0xf bank_mask:0xf
    v_and_b32_dpp v25, v55, v9 row_newbcast:0 row_mask:0xf bank_mask:0xf
    v_and_b32_dpp v26, v55, v10 row_newbcast:0 row_mask:0xf bank_mask:0xf
    v_and_b32_dpp v27, v55, v11 row_newbcast:0 row_mask:0xf bank_mask:0xf
    s_nop 1
    v_mfma_f32_16x16x32_bf16 v[20:23], v[24:27], v[136:139], v[20:23]
    s_waitcnt vmcnt(2)
    v_and_b32_dpp v28, v55, v8 row_newbcast:8 row_mask:0xf bank_mask:0xf
    v_and_b32_dpp v29, v55, v9 row_newbcast:8 row_mask:0xf bank_mask:0xf
    v_and_b32_dpp v30, v55, v10 row_newbcast:8 row_mask:0xf bank_mask:0xf
    v_and_b32_dpp v31, v55, v11 row_newbcast:8 row_mask:0xf bank_mask:0xf
    s_nop 1
    v_mfma_f32_16x16x32_bf16 v[20:23], v[28:31], v[140:143], v[20:23]
    s_waitcnt vmcnt(1)
    v_and_b32_dpp v24, v55, v8 row_newbcast:4 row_mask:0xf bank_mask:0xf
    v_and_b32_dpp v25, v55, v9 row_newbcast:4 row_mask:0xf bank_mask:0xf
    v_and_b32_dpp v26, v55, v10 row_newbcast:4 row_mask:0xf bank_mask:0xf
    v_and_b32_dpp v27, v55, v11 row_newbcast:4 row_mask:0xf bank_mask:0xf
    s_nop 1
    v_mfma_f32_16x16x32_bf16 v[20:23], v[24:27], v[144:147], v[20:23]
    s_waitcnt vmcnt(0)
    v_and_b32_dpp v28, v55, v8 row_newbcast:12 row_mask:0xf bank_mask:0xf
    v_and_b32_dpp v29, v55, v9 row_newbcast:12 row_mask:0xf bank_mask:0xf
    v_and_b32_dpp v30, v55, v10 row_newbcast:12 row_mask:0xf bank_mask:0xf
    v_and_b32_dpp v31, v55, v11 row_newbcast:12 row_mask:0xf bank_mask:0xf
    s_nop 1
    v_mfma_f32_16x16x32_bf16 v[20:23], v[28:31], v[148:151], v[20:23]
    s_nop 7
    v_cvt_pk_bf16_f32 v20, v20, v21
    v_cvt_pk_bf16_f32 v21, v22, v23
    s_mov_b32 exec_hi, 0
    ds_write_b64 v6, v[20:21]
    s_mov_b64 exec, -1
    s_waitcnt lgkmcnt(0)
    s_barrier
    s_endpgm
L_helper:
    v_and_b32 v1, 63, v0
    s_and_b32 s3, s2, 1
    s_mul_i32 s3, s3, 24
    s_add_u32 s3, s3, s51
    s_lshr_b32 s61, s50, 1
    s_load_dwordx2 s[44:45], s[0:1], 96
    s_load_dwordx2 s[32:33], s[0:1], 64
    s_load_dwordx2 s[28:29], s[0:1], 0
    s_load_dwordx2 s[12:13], s[0:1], 24
    s_load_dwordx2 s[16:17], s[0:1], 32
    s_load_dwordx2 s[20:21], s[0:1], 48
    s_load_dwordx2 s[24:25], s[0:1], 56
    s_load_dwordx2 s[40:41], s[0:1], 80
    s_mov_b32 s34, 4096
    s_mov_b32 s35, 0x20000
    s_mov_b32 s30, 4096
    s_mov_b32 s31, 0x20000
    s_mov_b32 s14, 4194304
    s_mov_b32 s15, 0x20000
    s_mov_b32 s46, 5242880
    s_mov_b32 s47, 0x20000
    v_lshrrev_b32 v2, 4, v1
    v_and_b32 v3, 15, v0
    v_lshlrev_b32 v10, 10, v2
    v_lshl_add_u32 v10, v3, 4, v10
    v_lshlrev_b32 v11, 4, v1
    v_lshrrev_b32 v4, 3, v1
    v_lshlrev_b32 v4, 13, v4
    v_and_b32 v5, 7, v0
    v_lshl_add_u32 v4, v5, 4, v4
    s_lshl_b32 s74, s52, 20
    s_lshl_b32 s75, s53, 8
    s_add_u32 s74, s74, s75
    s_lshl_b32 s75, s54, 7
    s_add_u32 s74, s74, s75
    s_lshl_b32 s75, s49, 15
    s_lshl_b32 s60, s52, 8
    v_mov_b32 v6, 163808
    v_mov_b32 v24, 0
    v_mov_b32 v25, 0
    v_mov_b32 v26, 0
    v_mov_b32 v27, 0
    ds_write_b128 v6, v[24:27]
    ds_write_b128 v6, v[24:27] offset:16
    s_waitcnt lgkmcnt(0)
    s_load_dword s48, s[44:45], 0
    s_cmp_lt_u32 s51, 24
    s_cbranch_scc1 L_p1u
    s_barrier
    s_waitcnt lgkmcnt(0)
    s_add_u32 s48, s48, 0x9e3779b1
    s_cmp_eq_u32 s49, 3
    s_cbranch_scc1 L_nop1b
    s_lshl_b32 s3, s49, 6
    s_and_b32 s56, s2, 63
    s_add_u32 s3, s3, s56
    s_lshl_b32 s72, s3, 11
    s_add_u32 s72, s72, 2097152
    s_lshl_b32 s3, s3, 8
    s_add_u32 s3, s3, 4096
    v_bfe_u32 v9, v0, 1, 2
    v_lshlrev_b32 v9, 7, v9
    v_bfe_u32 v12, v0, 3, 2
    v_lshl_add_u32 v9, v12, 5, v9
    v_and_b32 v12, 1, v0
    v_lshl_add_u32 v9, v12, 4, v9
    v_lshrrev_b32 v12, 5, v1
    v_lshl_add_u32 v9, v12, 9, v9
    v_lshlrev_b32 v12, 3, v1
    s_cmp_lg_u32 s49, 0
    s_cbranch_scc1 L_bgen
    s_cmp_ge_u32 s56, 32
    s_cbranch_scc1 L_nop1b
    v_bfe_u32 v13, v0, 3, 2
    v_lshlrev_b32 v13, 10, v13
    v_and_b32 v8, 7, v0
    v_lshl_add_u32 v15, v8, 2, v13
    v_lshl_add_u32 v13, v8, 4, v13
    v_lshrrev_b32 v8, 5, v1
    v_lshl_add_u32 v13, v8, 7, v13
    s_lshl_b32 s56, s56, 5
    buffer_load_dword v20, v15, s[28:31], s56 offen
    s_add_u32 s71, s72, 65536
    buffer_load_dwordx4 v[104:107], v13, s[28:31], 0 offen offset:0
    buffer_load_dwordx4 v[108:111], v13, s[28:31], 0 offen offset:256
    buffer_load_dwordx4 v[112:115], v13, s[28:31], 0 offen offset:512
    buffer_load_dwordx4 v[116:119], v13, s[28:31], 0 offen offset:768
    s_waitcnt vmcnt(0)
    v_lshlrev_b32 v136, 16, v104
    v_and_b32 v137, 0xffff0000, v104
    v_lshlrev_b32 v138, 16, v105
    v_and_b32 v139, 0xffff0000, v105
    v_lshlrev_b32 v140, 16, v106
    v_and_b32 v141, 0xffff0000, v106
    v_lshlrev_b32 v142, 16, v107
    v_and_b32 v143, 0xffff0000, v107
    v_lshlrev_b32 v144, 16, v108
    v_and_b32 v145, 0xffff0000, v108
    v_lshlrev_b32 v146, 16, v109
    v_and_b32 v147, 0xffff0000, v109
    v_lshlrev_b32 v148, 16, v110
    v_and_b32 v149, 0xffff0000, v110
    v_lshlrev_b32 v150, 16, v111
    v_and_b32 v151, 0xffff0000, v111
    v_lshlrev_b32 v152, 16, v112
    v_and_b32 v153, 0xffff0000, v112
    v_lshlrev_b32 v154, 16, v113
    v_and_b32 v155, 0xffff0000, v113
    v_lshlrev_b32 v156, 16, v114
    v_and_b32 v157, 0xffff0000, v114
    v_lshlrev_b32 v158, 16, v115
    v_and_b32 v159, 0xffff0000, v115
    v_lshlrev_b32 v160, 16, v116
    v_and_b32 v161, 0xffff0000, v116
    v_lshlrev_b32 v162, 16, v117
    v_and_b32 v163, 0xffff0000, v117
    v_lshlrev_b32 v164, 16, v118
    v_and_b32 v165, 0xffff0000, v118
    v_lshlrev_b32 v166, 16, v119
    v_and_b32 v167, 0xffff0000, v119
    v_pk_add_f32 v[104:105], v[136:137], v[152:153]
    v_pk_add_f32 v[106:107], v[138:139], v[154:155]
    v_pk_add_f32 v[108:109], v[140:141], v[156:157]
    v_pk_add_f32 v[110:111], v[142:143], v[158:159]
    v_pk_add_f32 v[112:113], v[144:145], v[160:161]
    v_pk_add_f32 v[114:115], v[146:147], v[162:163]
    v_pk_add_f32 v[116:117], v[148:149], v[164:165]
    v_pk_add_f32 v[118:119], v[150:151], v[166:167]
    v_pk_add_f32 v[104:105], v[104:105], v[112:113]
    v_pk_add_f32 v[106:107], v[106:107], v[114:115]
    v_pk_add_f32 v[108:109], v[108:109], v[116:117]
    v_pk_add_f32 v[110:111], v[110:111], v[118:119]
    v_pk_add_f32 v[104:105], v[104:105], v[108:109]
    v_pk_add_f32 v[106:107], v[106:107], v[110:111]
    v_pk_add_f32 v[104:105], v[104:105], v[106:107]
    v_add_f32 v16, v104, v105
    s_nop 1
    v_add_f32_dpp v16, v16, v16 quad_perm:[1,0,3,2] row_mask:0xf bank_mask:0xf
    s_nop 1
    v_add_f32_dpp v16, v16, v16 quad_perm:[2,3,0,1] row_mask:0xf bank_mask:0xf
    s_nop 1
    v_add_f32_dpp v16, v16, v16 row_half_mirror row_mask:0xf bank_mask:0xf
    v_mov_b32 v19, v16
    s_nop 1
    v_permlane32_swap_b32 v16, v19
    v_add_f32 v16, v16, v19
    v_mul_f32 v16, 0x3b000000, v16
    v_sub_f32 v136, v136, v16
    v_sub_f32 v137, v137, v16
    v_sub_f32 v138, v138, v16
    v_sub_f32 v139, v139, v16
    v_sub_f32 v140, v140, v16
    v_sub_f32 v141, v141, v16
    v_sub_f32 v142, v142, v16
    v_sub_f32 v143, v143, v16
    v_sub_f32 v144, v144, v16
    v_sub_f32 v145, v145, v16
    v_sub_f32 v146, v146, v16
    v_sub_f32 v147, v147, v16
    v_sub_f32 v148, v148, v16
    v_sub_f32 v149, v149, v16
    v_sub_f32 v150, v150, v16
    v_sub_f32 v151, v151, v16
    v_sub_f32 v152, v152, v16
    v_sub_f32 v153, v153, v16
    v_sub_f32 v154, v154, v16
    v_sub_f32 v155, v155, v16
    v_sub_f32 v156, v156, v16
    v_sub_f32 v157, v157, v16
    v_sub_f32 v158, v158, v16
    v_sub_f32 v159, v159, v16
    v_sub_f32 v160, v160, v16
    v_sub_f32 v161, v161, v16
    v_sub_f32 v162, v162, v16
    v_sub_f32 v163, v163, v16
    v_sub_f32 v164, v164, v16
    v_sub_f32 v165, v165, v16
    v_sub_f32 v166, v166, v16
    v_sub_f32 v167, v167, v16
    v_mul_f32 v17, v136, v136
    v_mul_f32 v18, v137, v137
    v_fmac_f32 v17, v138, v138
    v_fmac_f32 v18, v139, v139
    v_fmac_f32 v17, v140, v140
    v_fmac_f32 v18, v141, v141
    v_fmac_f32 v17, v142, v142
    v_fmac_f32 v18, v143, v143
    v_fmac_f32 v17, v144, v144
    v_fmac_f32 v18, v145, v145
    v_fmac_f32 v17, v146, v146
    v_fmac_f32 v18, v147, v147
    v_fmac_f32 v17, v148, v148
    v_fmac_f32 v18, v149, v149
    v_fmac_f32 v17, v150, v150
    v_fmac_f32 v18, v151, v151
    v_fmac_f32 v17, v152, v152
    v_fmac_f32 v18, v153, v153
    v_fmac_f32 v17, v154, v154
    v_fmac_f32 v18, v155, v155
    v_fmac_f32 v17, v156, v156
    v_fmac_f32 v18, v157, v157
    v_fmac_f32 v17, v158, v158
    v_fmac_f32 v18, v159, v159
    v_fmac_f32 v17, v160, v160
    v_fmac_f32 v18, v161, v161
    v_fmac_f32 v17, v162, v162
    v_fmac_f32 v18, v163, v163
    v_fmac_f32 v17, v164, v164
    v_fmac_f32 v18, v165, v165
    v_fmac_f32 v17, v166, v166
    v_fmac_f32 v18, v167, v167
    v_add_f32 v17, v17, v18
    s_nop 1
    v_add_f32_dpp v17, v17, v17 quad_perm:[1,0,3,2] row_mask:0xf bank_mask:0xf
    s_nop 1
    v_add_f32_dpp v17, v17, v17 quad_perm:[2,3,0,1] row_mask:0xf bank_mask:0xf
    s_nop 1
    v_add_f32_dpp v17, v17, v17 row_half_mirror row_mask:0xf bank_mask:0xf
    v_mov_b32 v19, v17
    s_nop 1
    v_permlane32_swap_b32 v17, v19
    v_add_f32 v17, v17, v19
    v_mov_b32 v18, 0x3727c5ac
    v_fmac_f32 v18, 0x3b000000, v17
    v_rsq_f32 v17, v18
    v_lshlrev_b32 v22, 16, v20
    v_and_b32 v23, 0xffff0000, v20
    v_sub_f32 v22, v22, v16
    v_sub_f32 v23, v23, v16
    v_mul_f32 v22, v22, v17
    v_mul_f32 v23, v23, v17
    s_mov_b32 s57, 262144
L_gate0h:
    ds_read_b32 v8, v6 offset:0
    s_waitcnt lgkmcnt(0)
    v_readfirstlane_b32 s56, v8
    s_cmp_lg_u32 s56, 0
    s_cbranch_scc1 L_gate0hx
    s_sleep 2
    s_sub_u32 s57, s57, 1
    s_cbranch_scc0 L_gate0h
L_gate0hx:
    s_mov_b64 s[58:59], -1
    s_mov_b64 s[60:61], -1
    s_mov_b64 s[62:63], -1
    s_mov_b64 s[64:65], -1
    s_mov_b32 s57, 32768
L_g1:
    s_mov_b64 exec, s[58:59]
    s_cbranch_execz L_g1_0
    buffer_load_dwordx4 v[24:27], v9, s[44:47], s72 offen offset:0 sc1
L_g1_0:
    s_mov_b64 exec, s[60:61]
    s_cbranch_execz L_g1_1
    buffer_load_dwordx4 v[28:31], v9, s[44:47], s72 offen offset:1024 sc1
L_g1_1:
    s_mov_b64 exec, s[62:63]
    s_cbranch_execz L_g1_2
    buffer_load_dwordx4 v[32:35], v9, s[44:47], s71 offen offset:0 sc1
L_g1_2:
    s_mov_b64 exec, s[64:65]
    s_cbranch_execz L_g1_3
    buffer_load_dwordx4 v[36:39], v9, s[44:47], s71 offen offset:1024 sc1
L_g1_3:
    s_waitcnt vmcnt(0)
    s_mov_b64 exec, s[58:59]
    v_cmp_ne_u32 s[58:59], s48, v25
    v_cmp_ne_u32 vcc, s48, v27
    s_or_b64 s[58:59], s[58:59], vcc
    s_mov_b64 exec, s[60:61]
    v_cmp_ne_u32 s[60:61], s48, v29
    v_cmp_ne_u32 vcc, s48, v31
    s_or_b64 s[60:61], s[60:61], vcc
    s_mov_b64 exec, s[62:63]
    v_cmp_ne_u32 s[62:63], s48, v33
    v_cmp_ne_u32 vcc, s48, v35
    s_or_b64 s[62:63], s[62:63], vcc
    s_mov_b64 exec, s[64:65]
    v_cmp_ne_u32 s[64:65], s48, v37
    v_cmp_ne_u32 vcc, s48, v39
    s_or_b64 s[64:65], s[64:65], vcc
    s_or_b64 s[100:101], s[58:59], s[58:59]
    s_or_b64 s[100:101], s[100:101], s[60:61]
    s_or_b64 s[100:101], s[100:101], s[62:63]
    s_or_b64 s[100:101], s[100:101], s[64:65]
    s_cbranch_scc0 L_g1_x
    s_sleep 4
    s_sub_u32 s57, s57, 1
    s_cbranch_scc0 L_g1
L_g1_x:
    s_mov_b64 exec, -1
    v_add_f32 v24, v24, v28
    v_add_f32 v26, v26, v30
    v_add_f32 v32, v32, v36
    v_add_f32 v34, v34, v38
    v_mov_b32 v28, v24
    v_mov_b32 v30, v26
    v_mov_b32 v36, v32
    v_mov_b32 v38, v34
    v_permlane32_swap_b32 v24, v28
    v_permlane32_swap_b32 v26, v30
    v_permlane32_swap_b32 v32, v36
    v_permlane32_swap_b32 v34, v38
    v_add_f32 v24, v24, v28
    v_add_f32 v26, v26, v30
    v_add_f32 v32, v32, v36
    v_add_f32 v34, v34, v38
    v_add_f32 v32, 1.0, v32
    v_add_f32 v34, 1.0, v34
    v_fmac_f32 v24, v22, v32
    v_fmac_f32 v26, v23, v34
    s_branch L_bpub
L_bgen:
    s_mov_b32 s57, 262144
L_gate0:
    ds_read_b32 v8, v6 offset:0
    s_waitcnt lgkmcnt(0)
    v_readfirstlane_b32 s56, v8
    s_cmp_lg_u32 s56, 0
    s_cbranch_scc1 L_gate0x
    s_sleep 2
    s_sub_u32 s57, s57, 1
    s_cbranch_scc0 L_gate0
L_gate0x:
    s_mov_b64 s[58:59], -1
    s_mov_b64 s[60:61], -1
    s_mov_b32 s57, 32768
L_g2:
    s_mov_b64 exec, s[58:59]
    s_cbranch_execz L_g2_0
    buffer_load_dwordx4 v[24:27], v9, s[44:47], s72 offen offset:0 sc1
L_g2_0:
    s_mov_b64 exec, s[60:61]
    s_cbranch_execz L_g2_1
    buffer_load_dwordx4 v[28:31], v9, s[44:47], s72 offen offset:1024 sc1
L_g2_1:
    s_waitcnt vmcnt(0)
    s_mov_b64 exec, s[58:59]
    v_cmp_ne_u32 s[58:59], s48, v25
    v_cmp_ne_u32 vcc, s48, v27
    s_or_b64 s[58:59], s[58:59], vcc
    s_mov_b64 exec, s[60:61]
    v_cmp_ne_u32 s[60:61], s48, v29
    v_cmp_ne_u32 vcc, s48, v31
    s_or_b64 s[60:61], s[60:61], vcc
    s_or_b64 s[100:101], s[58:59], s[58:59]
    s_or_b64 s[100:101], s[100:101], s[60:61]
    s_cbranch_scc0 L_g2_x
    s_sleep 4
    s_sub_u32 s57, s57, 1
    s_cbranch_scc0 L_g2
L_g2_x:
    s_mov_b64 exec, -1
    v_add_f32 v24, v24, v28
    v_add_f32 v26, v26, v30
    v_mov_b32 v28, v24
    v_mov_b32 v30, v26
    s_nop 0
    v_permlane32_swap_b32 v24, v28
    v_permlane32_swap_b32 v26, v30
    v_add_f32 v24, v24, v28
    v_add_f32 v26, v26, v30
L_bpub:
    v_cvt_pk_bf16_f32 v24, v24, v26
    s_mov_b32 exec_hi, 0
    buffer_store_dwordx2 v[24:25], v12, s[44:47], s3 offen sc1
    s_mov_b64 exec, -1
    s_branch L_nop1b
L_p1u:
    s_lshl_b32 s59, s61, 8
    buffer_load_dwordx4 v[16:19], v10, s[32:35], s59 offen
    s_barrier
    v_bfe_u32 v12, v0, 2, 2
    v_lshlrev_b32 v12, 7, v12
    v_lshl_add_u32 v12, v2, 10, v12
    v_and_b32 v13, 3, v0
    v_lshl_add_u32 v12, v13, 3, v12
    s_lshl_b32 s56, s49, 5
    s_add_u32 s56, s56, 131072
    v_add_u32 v12, s56, v12
    v_lshlrev_b32 v13, 3, v1
    s_lshl_b32 s3, s3, 2
    s_add_u32 s3, s3, s49
    s_lshl_b32 s3, s3, 2
    s_add_u32 s3, s3, s61
    s_lshl_b32 s3, s3, 9
    s_add_u32 s3, s3, 2097152
    s_waitcnt vmcnt(0)
    v_lshlrev_b32 v24, 16, v16
    v_and_b32 v25, 0xffff0000, v16
    v_lshlrev_b32 v26, 16, v17
    v_and_b32 v27, 0xffff0000, v17
    v_lshlrev_b32 v28, 16, v18
    v_and_b32 v29, 0xffff0000, v18
    v_lshlrev_b32 v30, 16, v19
    v_and_b32 v31, 0xffff0000, v19
    v_mul_f32 v32, 0xbfb8aa3b, v24
    v_mul_f32 v33, 0xbfb8aa3b, v25
    v_mul_f32 v34, 0xbfb8aa3b, v26
    v_mul_f32 v35, 0xbfb8aa3b, v27
    v_mul_f32 v36, 0xbfb8aa3b, v28
    v_mul_f32 v37, 0xbfb8aa3b, v29
    v_mul_f32 v38, 0xbfb8aa3b, v30
    v_mul_f32 v39, 0xbfb8aa3b, v31
    v_exp_f32 v32, v32
    v_exp_f32 v33, v33
    v_exp_f32 v34, v34
    v_exp_f32 v35, v35
    v_exp_f32 v36, v36
    v_exp_f32 v37, v37
    v_exp_f32 v38, v38
    v_exp_f32 v39, v39
    v_add_f32 v32, 1.0, v32
    v_add_f32 v33, 1.0, v33
    v_add_f32 v34, 1.0, v34
    v_add_f32 v35, 1.0, v35
    v_add_f32 v36, 1.0, v36
    v_add_f32 v37, 1.0, v37
    v_add_f32 v38, 1.0, v38
    v_add_f32 v39, 1.0, v39
    v_rcp_f32 v32, v32
    v_rcp_f32 v33, v33
    v_rcp_f32 v34, v34
    v_rcp_f32 v35, v35
    v_rcp_f32 v36, v36
    v_rcp_f32 v37, v37
    v_rcp_f32 v38, v38
    v_rcp_f32 v39, v39
    v_mul_f32 v24, v24, v32
    v_mul_f32 v25, v25, v33
    v_mul_f32 v26, v26, v34
    v_mul_f32 v27, v27, v35
    v_mul_f32 v28, v28, v36
    v_mul_f32 v29, v29, v37
    v_mul_f32 v30, v30, v38
    v_mul_f32 v31, v31, v39
    v_cvt_pk_bf16_f32 v24, v24, v25
    v_cvt_pk_bf16_f32 v25, v26, v27
    v_cvt_pk_bf16_f32 v26, v28, v29
    v_cvt_pk_bf16_f32 v27, v30, v31
    s_lshl_b32 s56, s49, 10
    s_add_u32 s56, s56, 147456
    v_add_u32 v8, s56, v11
    ds_write_b128 v8, v[24:27]
    v_bfe_u32 v9, v0, 2, 2
    v_lshl_add_u32 v9, v9, 8, s56
    v_lshl_add_u32 v9, v2, 4, v9
    ds_read_b128 v[24:27], v9 offset:0
    ds_read_b128 v[28:31], v9 offset:64
    ds_read_b128 v[32:35], v9 offset:128
    ds_read_b128 v[36:39], v9 offset:192
    s_waitcnt lgkmcnt(0)
    s_add_u32 s48, s48, 0x9e3779b1
    ds_read_b64_tr_b16 v[48:49], v12 offset:0
    ds_read_b64_tr_b16 v[50:51], v12 offset:512
    ds_read_b64_tr_b16 v[52:53], v12 offset:4096
    ds_read_b64_tr_b16 v[54:55], v12 offset:4608
    ds_read_b64_tr_b16 v[56:57], v12 offset:8192
    ds_read_b64_tr_b16 v[58:59], v12 offset:8704
    ds_read_b64_tr_b16 v[60:61], v12 offset:12288
    ds_read_b64_tr_b16 v[62:63], v12 offset:12800
    v_mov_b32 v45, s48
    s_waitcnt lgkmcnt(0)
    v_mfma_f32_16x16x32_bf16 v[40:43], v[48:51], v[24:27], 0
    v_mfma_f32_16x16x32_bf16 v[40:43], v[52:55], v[28:31], v[40:43]
    v_mfma_f32_16x16x32_bf16 v[40:43], v[56:59], v[32:35], v[40:43]
    v_mfma_f32_16x16x32_bf16 v[40:43], v[60:63], v[36:39], v[40:43]
    s_mov_b32 exec_lo, 0x11111111
    s_mov_b32 exec_hi, 0x11111111
    s_nop 5
    v_mov_b32 v44, v40
    s_mov_b32 exec_lo, 0x22222222
    s_mov_b32 exec_hi, 0x22222222
    v_mov_b32 v44, v41
    s_mov_b32 exec_lo, 0x44444444
    s_mov_b32 exec_hi, 0x44444444
    v_mov_b32 v44, v42
    s_mov_b32 exec_lo, 0x88888888
    s_mov_b32 exec_hi, 0x88888888
    v_mov_b32 v44, v43
    s_mov_b64 exec, -1
    buffer_store_dwordx2 v[44:45], v13, s[44:47], s3 offen sc1
L_nop1b:
    s_mov_b32 s18, 4194304
    s_mov_b32 s19, 0x20000
    s_mov_b32 s22, 1835008
    s_mov_b32 s23, 0x20000
    s_mov_b32 s26, 1835008
    s_mov_b32 s27, 0x20000
    s_mov_b32 s42, 4096
    s_mov_b32 s43, 0x20000
    s_cmp_lg_u32 s49, 3
    s_cbranch_scc1 L_nq2
    s_add_u32 s56, s74, 0
    s_add_u32 m0, s75, 0
    s_nop 0
    buffer_load_dwordx4 v4, s[12:15], s56 offen  lds
    s_add_u32 s56, s74, 65536
    s_add_u32 m0, s75, 1024
    s_nop 0
    buffer_load_dwordx4 v4, s[12:15], s56 offen  lds
    s_add_u32 s56, s74, 131072
    s_add_u32 m0, s75, 2048
    s_nop 0
    buffer_load_dwordx4 v4, s[12:15], s56 offen  lds
    s_add_u32 s56, s74, 196608
    s_add_u32 m0, s75, 3072
    s_nop 0
    buffer_load_dwordx4 v4, s[12:15], s56 offen  lds
    s_add_u32 s56, s74, 262144
    s_add_u32 m0, s75, 4096
    s_nop 0
    buffer_load_dwordx4 v4, s[12:15], s56 offen  lds
    s_add_u32 s56, s74, 327680
    s_add_u32 m0, s75, 5120
    s_nop 0
    buffer_load_dwordx4 v4, s[12:15], s56 offen  lds
    s_add_u32 s56, s74, 393216
    s_add_u32 m0, s75, 6144
    s_nop 0
    buffer_load_dwordx4 v4, s[12:15], s56 offen  lds
    s_add_u32 s56, s74, 458752
    s_add_u32 m0, s75, 7168
    s_nop 0
    buffer_load_dwordx4 v4, s[12:15], s56 offen  lds
    s_waitcnt vmcnt(7)
    s_add_u32 s56, s74, 524288
    s_add_u32 m0, s75, 8192
    s_nop 0
    buffer_load_dwordx4 v4, s[12:15], s56 offen  lds
    s_waitcnt vmcnt(7)
    s_add_u32 s56, s74, 589824
    s_add_u32 m0, s75, 9216
    s_nop 0
    buffer_load_dwordx4 v4, s[12:15], s56 offen  lds
    s_waitcnt vmcnt(7)
    s_add_u32 s56, s74, 655360
    s_add_u32 m0, s75, 10240
    s_nop 0
    buffer_load_dwordx4 v4, s[12:15], s56 offen  lds
    s_waitcnt vmcnt(7)
    s_add_u32 s56, s74, 720896
    s_add_u32 m0, s75, 11264
    s_nop 0
    buffer_load_dwordx4 v4, s[12:15], s56 offen  lds
    s_waitcnt vmcnt(7)
    s_add_u32 s56, s74, 786432
    s_add_u32 m0, s75, 12288
    s_nop 0
    buffer_load_dwordx4 v4, s[12:15], s56 offen  lds
    s_waitcnt vmcnt(7)
    s_add_u32 s56, s74, 851968
    s_add_u32 m0, s75, 13312
    s_nop 0
    buffer_load_dwordx4 v4, s[12:15], s56 offen  lds
    s_waitcnt vmcnt(7)
    s_add_u32 s56, s74, 917504
    s_add_u32 m0, s75, 14336
    s_nop 0
    buffer_load_dwordx4 v4, s[12:15], s56 offen  lds
    s_waitcnt vmcnt(7)
    s_add_u32 s56, s74, 983040
    s_add_u32 m0, s75, 15360
    s_nop 0
    buffer_load_dwordx4 v4, s[12:15], s56 offen  lds
    v_bfe_u32 v8, v0, 2, 2
    v_lshlrev_b32 v9, 7, v8
    v_lshl_add_u32 v9, v2, 10, v9
    v_and_b32 v12, 3, v0
    v_lshl_add_u32 v9, v12, 3, v9
    v_add_u32 v9, s75, v9
    s_lshl_b32 s56, s49, 10
    s_add_u32 s56, s56, 147456
    v_lshl_add_u32 v13, v8, 8, s56
    v_lshl_add_u32 v13, v2, 5, v13
    v_lshl_add_u32 v13, v12, 3, v13
    v_lshl_add_u32 v14, v12, 8, s56
    v_lshl_add_u32 v14, v2, 4, v14
    v_lshlrev_b32 v12, 3, v1
    v_lshlrev_b32 v15, 2, v1
    v_add_u32 v15, 153600, v15
    s_lshl_b32 s72, s52, 11
    s_add_u32 s72, s72, 4096
    s_lshl_b32 s73, s53, 14
    s_add_u32 s73, s73, 1310720
    s_lshl_b32 s56, s52, 10
    s_add_u32 s66, s73, s56
    s_lshl_b32 s56, s54, 9
    s_add_u32 s66, s66, s56
    s_add_u32 s67, s66, 4096
    s_add_u32 s68, s66, 8192
    s_add_u32 s69, s66, 12288
    s_lshl_b32 s56, s52, 12
    s_add_u32 s73, s73, s56
    s_waitcnt vmcnt(0)
    ds_read_b64_tr_b16 v[40:41], v9 offset:0
    ds_read_b64_tr_b16 v[42:43], v9 offset:512
    ds_read_b64_tr_b16 v[44:45], v9 offset:4096
    ds_read_b64_tr_b16 v[46:47], v9 offset:4608
    ds_read_b64_tr_b16 v[48:49], v9 offset:8192
    ds_read_b64_tr_b16 v[50:51], v9 offset:8704
    ds_read_b64_tr_b16 v[52:53], v9 offset:12288
    ds_read_b64_tr_b16 v[54:55], v9 offset:12800
    ds_read_b64_tr_b16 v[56:57], v9 offset:32
    ds_read_b64_tr_b16 v[58:59], v9 offset:544
    ds_read_b64_tr_b16 v[60:61], v9 offset:4128
    ds_read_b64_tr_b16 v[62:63], v9 offset:4640
    ds_read_b64_tr_b16 v[64:65], v9 offset:8224
    ds_read_b64_tr_b16 v[66:67], v9 offset:8736
    ds_read_b64_tr_b16 v[68:69], v9 offset:12320
    ds_read_b64_tr_b16 v[70:71], v9 offset:12832
    ds_read_b64_tr_b16 v[72:73], v9 offset:64
    ds_read_b64_tr_b16 v[74:75], v9 offset:576
    ds_read_b64_tr_b16 v[76:77], v9 offset:4160
    ds_read_b64_tr_b16 v[78:79], v9 offset:4672
    ds_read_b64_tr_b16 v[80:81], v9 offset:8256
    ds_read_b64_tr_b16 v[82:83], v9 offset:8768
    ds_read_b64_tr_b16 v[84:85], v9 offset:12352
    ds_read_b64_tr_b16 v[86:87], v9 offset:12864
    ds_read_b64_tr_b16 v[88:89], v9 offset:96
    ds_read_b64_tr_b16 v[90:91], v9 offset:608
    ds_read_b64_tr_b16 v[92:93], v9 offset:4192
    ds_read_b64_tr_b16 v[94:95], v9 offset:4704
    ds_read_b64_tr_b16 v[96:97], v9 offset:8288
    ds_read_b64_tr_b16 v[98:99], v9 offset:8800
    ds_read_b64_tr_b16 v[100:101], v9 offset:12384
    ds_read_b64_tr_b16 v[102:103], v9 offset:12896
    v_mov_b32 v153, s48
    v_mov_b32 v155, s48
    v_mov_b32 v157, s48
    v_mov_b32 v159, s48
    s_mov_b32 s57, 262144
L_gate1:
    ds_read_b32 v8, v6 offset:4
    s_waitcnt lgkmcnt(0)
    v_readfirstlane_b32 s56, v8
    s_cmp_lg_u32 s56, 0
    s_cbranch_scc1 L_gate1x
    s_sleep 2
    s_sub_u32 s57, s57, 1
    s_cbranch_scc0 L_gate1
L_gate1x:
    s_mov_b64 s[58:59], -1
    s_mov_b64 s[60:61], -1
    s_mov_b32 s57, 32768
L_g3:
    s_mov_b64 exec, s[58:59]
    s_cbranch_execz L_g3_0
    buffer_load_dwordx4 v[24:27], v11, s[44:47], s72 offen offset:0 sc1
L_g3_0:
    s_mov_b64 exec, s[60:61]
    s_cbranch_execz L_g3_1
    buffer_load_dwordx4 v[28:31], v11, s[44:47], s72 offen offset:1024 sc1
L_g3_1:
    s_waitcnt vmcnt(0)
    s_mov_b64 exec, s[58:59]
    v_cmp_ne_u32 s[58:59], s48, v25
    v_cmp_ne_u32 vcc, s48, v27
    s_or_b64 s[58:59], s[58:59], vcc
    s_mov_b64 exec, s[60:61]
    v_cmp_ne_u32 s[60:61], s48, v29
    v_cmp_ne_u32 vcc, s48, v31
    s_or_b64 s[60:61], s[60:61], vcc
    s_or_b64 s[100:101], s[58:59], s[58:59]
    s_or_b64 s[100:101], s[100:101], s[60:61]
    s_cbranch_scc0 L_g3_x
    s_sleep 4
    s_sub_u32 s57, s57, 1
    s_cbranch_scc0 L_g3
L_g3_x:
    s_mov_b64 exec, -1
    v_mov_b32 v25, v26
    v_mov_b32 v29, v30
    ds_write_b64 v13, v[24:25]
    ds_write_b64 v13, v[28:29] offset:128
    ds_read_b128 v[24:27], v14 offset:0
    ds_read_b128 v[28:31], v14 offset:64
    ds_read_b128 v[32:35], v14 offset:128
    ds_read_b128 v[36:39], v14 offset:192
    s_waitcnt lgkmcnt(3)
    v_mfma_f32_16x16x32_bf16 v[104:107], v[24:27], v[40:43], 0
    v_mfma_f32_16x16x32_bf16 v[108:111], v[24:27], v[56:59], 0
    v_mfma_f32_16x16x32_bf16 v[112:115], v[24:27], v[72:75], 0
    v_mfma_f32_16x16x32_bf16 v[116:119], v[24:27], v[88:91], 0
    s_waitcnt lgkmcnt(2)
    v_mfma_f32_16x16x32_bf16 v[104:107], v[28:31], v[44:47], v[104:107]
    v_mfma_f32_16x16x32_bf16 v[108:111], v[28:31], v[60:63], v[108:111]
    v_mfma_f32_16x16x32_bf16 v[112:115], v[28:31], v[76:79], v[112:115]
    v_mfma_f32_16x16x32_bf16 v[116:119], v[28:31], v[92:95], v[116:119]
    s_waitcnt lgkmcnt(1)
    v_mfma_f32_16x16x32_bf16 v[104:107], v[32:35], v[48:51], v[104:107]
    v_mfma_f32_16x16x32_bf16 v[108:111], v[32:35], v[64:67], v[108:111]
    v_mfma_f32_16x16x32_bf16 v[112:115], v[32:35], v[80:83], v[112:115]
    v_mfma_f32_16x16x32_bf16 v[116:119], v[32:35], v[96:99], v[116:119]
    s_waitcnt lgkmcnt(0)
    v_mfma_f32_16x16x32_bf16 v[104:107], v[36:39], v[52:55], v[104:107]
    v_mfma_f32_16x16x32_bf16 v[108:111], v[36:39], v[68:71], v[108:111]
    v_mfma_f32_16x16x32_bf16 v[112:115], v[36:39], v[84:87], v[112:115]
    v_mfma_f32_16x16x32_bf16 v[116:119], v[36:39], v[100:103], v[116:119]
    s_mov_b32 exec_lo, 0xffff
    s_mov_b32 exec_hi, 0x0
    s_nop 2
    v_mov_b32 v152, v104
    v_mov_b32 v154, v105
    v_mov_b32 v156, v106
    v_mov_b32 v158, v107
    s_mov_b32 exec_lo, 0xffff0000
    s_mov_b32 exec_hi, 0x0
    v_mov_b32 v152, v108
    v_mov_b32 v154, v109
    v_mov_b32 v156, v110
    v_mov_b32 v158, v111
    s_mov_b32 exec_lo, 0x0
    s_mov_b32 exec_hi, 0xffff
    v_mov_b32 v152, v112
    v_mov_b32 v154, v113
    v_mov_b32 v156, v114
    v_mov_b32 v158, v115
    s_mov_b32 exec_lo, 0x0
    s_mov_b32 exec_hi, 0xffff0000
    v_mov_b32 v152, v116
    v_mov_b32 v154, v117
    v_mov_b32 v156, v118
    v_mov_b32 v158, v119
    s_mov_b64 exec, -1
    buffer_store_dwordx2 v[152:153], v12, s[44:47], s66 offen sc1
    buffer_store_dwordx2 v[154:155], v12, s[44:47], s67 offen sc1
    buffer_store_dwordx2 v[156:157], v12, s[44:47], s68 offen sc1
    buffer_store_dwordx2 v[158:159], v12, s[44:47], s69 offen sc1
    s_mov_b32 s57, 262144
L_gate2:
    ds_read_b32 v8, v6 offset:8
    s_waitcnt lgkmcnt(0)
    v_readfirstlane_b32 s56, v8
    s_cmp_lg_u32 s56, 0
    s_cbranch_scc1 L_gate2x
    s_sleep 2
    s_sub_u32 s57, s57, 1
    s_cbranch_scc0 L_gate2
L_gate2x:
    s_mov_b64 s[58:59], -1
    s_mov_b64 s[60:61], -1
    s_mov_b64 s[62:63], -1
    s_mov_b64 s[64:65], -1
    s_mov_b32 s57, 32768
L_g4:
    s_mov_b64 exec, s[58:59]
    s_cbranch_execz L_g4_0
    buffer_load_dwordx4 v[24:27], v11, s[44:47], s73 offen offset:0 sc1
L_g4_0:
    s_mov_b64 exec, s[60:61]
    s_cbranch_execz L_g4_1
    buffer_load_dwordx4 v[28:31], v11, s[44:47], s73 offen offset:1024 sc1
L_g4_1:
    s_mov_b64 exec, s[62:63]
    s_cbranch_execz L_g4_2
    buffer_load_dwordx4 v[32:35], v11, s[44:47], s73 offen offset:2048 sc1
L_g4_2:
    s_mov_b64 exec, s[64:65]
    s_cbranch_execz L_g4_3
    buffer_load_dwordx4 v[36:39], v11, s[44:47], s73 offen offset:3072 sc1
L_g4_3:
    s_waitcnt vmcnt(0)
    s_mov_b64 exec, s[58:59]
    v_cmp_ne_u32 s[58:59], s48, v25
    v_cmp_ne_u32 vcc, s48, v27
    s_or_b64 s[58:59], s[58:59], vcc
    s_mov_b64 exec, s[60:61]
    v_cmp_ne_u32 s[60:61], s48, v29
    v_cmp_ne_u32 vcc, s48, v31
    s_or_b64 s[60:61], s[60:61], vcc
    s_mov_b64 exec, s[62:63]
    v_cmp_ne_u32 s[62:63], s48, v33
    v_cmp_ne_u32 vcc, s48, v35
    s_or_b64 s[62:63], s[62:63], vcc
    s_mov_b64 exec, s[64:65]
    v_cmp_ne_u32 s[64:65], s48, v37
    v_cmp_ne_u32 vcc, s48, v39
    s_or_b64 s[64:65], s[64:65], vcc
    s_or_b64 s[100:101], s[58:59], s[58:59]
    s_or_b64 s[100:101], s[100:101], s[60:61]
    s_or_b64 s[100:101], s[100:101], s[62:63]
    s_or_b64 s[100:101], s[100:101], s[64:65]
    s_cbranch_scc0 L_g4_x
    s_sleep 4
    s_sub_u32 s57, s57, 1
    s_cbranch_scc0 L_g4
L_g4_x:
    s_mov_b64 exec, -1
    v_add_f32 v24, v24, v28
    v_add_f32 v26, v26, v30
    v_add_f32 v32, v32, v36
    v_add_f32 v34, v34, v38
    v_add_f32 v24, v24, v32
    v_add_f32 v26, v26, v34
    v_cvt_pk_bf16_f32 v24, v24, v26
    ds_write_b32 v15, v24
L_nq2:
    s_waitcnt vmcnt(0) lgkmcnt(0)
    s_barrier
    s_barrier
    v_lshlrev_b32 v4, 1, v2
    v_xor_b32 v4, v4, v3
    v_lshlrev_b32 v4, 4, v4
    v_lshl_add_u32 v4, v2, 10, v4
    v_xor_b32 v5, 128, v4
    s_lshl_b32 s72, s52, 1
    s_add_u32 s72, s72, s54
    s_lshl_b32 s72, s72, 12
    s_lshl_b32 s74, s53, 17
    s_lshl_b32 s56, s49, 8
    s_add_u32 s74, s74, s56
    s_add_u32 s57, s72, 0
    s_and_b32 s57, s57, 0x7fff
    s_lshl_b32 s56, s57, 2
    s_add_u32 s56, s56, s74
    s_add_u32 m0, s75, s57
    s_nop 0
    buffer_load_dwordx4 v4, s[16:19], s56 offen  lds
    s_add_u32 s57, s72, 1024
    s_and_b32 s57, s57, 0x7fff
    s_lshl_b32 s56, s57, 2
    s_add_u32 s56, s56, s74
    s_add_u32 m0, s75, s57
    s_nop 0
    buffer_load_dwordx4 v4, s[16:19], s56 offen  lds
    s_add_u32 s57, s72, 2048
    s_and_b32 s57, s57, 0x7fff
    s_lshl_b32 s56, s57, 2
    s_add_u32 s56, s56, s74
    s_add_u32 m0, s75, s57
    s_nop 0
    buffer_load_dwordx4 v5, s[16:19], s56 offen  lds
    s_add_u32 s57, s72, 3072
    s_and_b32 s57, s57, 0x7fff
    s_lshl_b32 s56, s57, 2
    s_add_u32 s56, s56, s74
    s_add_u32 m0, s75, s57
    s_nop 0
    buffer_load_dwordx4 v5, s[16:19], s56 offen  lds
    s_add_u32 s57, s72, 4096
    s_and_b32 s57, s57, 0x7fff
    s_lshl_b32 s56, s57, 2
    s_add_u32 s56, s56, s74
    s_add_u32 m0, s75, s57
    s_nop 0
    buffer_load_dwordx4 v4, s[16:19], s56 offen  lds
    s_waitcnt vmcnt(4)
    s_add_u32 s57, s72, 5120
    s_and_b32 s57, s57, 0x7fff
    s_lshl_b32 s56, s57, 2
    s_add_u32 s56, s56, s74
    s_add_u32 m0, s75, s57
    s_nop 0
    buffer_load_dwordx4 v4, s[16:19], s56 offen  lds
    s_waitcnt vmcnt(4)
    s_add_u32 s57, s72, 6144
    s_and_b32 s57, s57, 0x7fff
    s_lshl_b32 s56, s57, 2
    s_add_u32 s56, s56, s74
    s_add_u32 m0, s75, s57
    s_nop 0
    buffer_load_dwordx4 v5, s[16:19], s56 offen  lds
    s_waitcnt vmcnt(4)
    s_add_u32 s57, s72, 7168
    s_and_b32 s57, s57, 0x7fff
    s_lshl_b32 s56, s57, 2
    s_add_u32 s56, s56, s74
    s_add_u32 m0, s75, s57
    s_nop 0
    buffer_load_dwordx4 v5, s[16:19], s56 offen  lds
    s_waitcnt vmcnt(4)
    s_add_u32 s57, s72, 8192
    s_and_b32 s57, s57, 0x7fff
    s_lshl_b32 s56, s57, 2
    s_add_u32 s56, s56, s74
    s_add_u32 m0, s75, s57
    s_nop 0
    buffer_load_dwordx4 v4, s[16:19], s56 offen  lds
    s_waitcnt vmcnt(4)
    s_add_u32 s57, s72, 9216
    s_and_b32 s57, s57, 0x7fff
    s_lshl_b32 s56, s57, 2
    s_add_u32 s56, s56, s74
    s_add_u32 m0, s75, s57
    s_nop 0
    buffer_load_dwordx4 v4, s[16:19], s56 offen  lds
    s_waitcnt vmcnt(4)
    s_add_u32 s57, s72, 10240
    s_and_b32 s57, s57, 0x7fff
    s_lshl_b32 s56, s57, 2
    s_add_u32 s56, s56, s74
    s_add_u32 m0, s75, s57
    s_nop 0
    buffer_load_dwordx4 v5, s[16:19], s56 offen  lds
    s_waitcnt vmcnt(4)
    s_add_u32 s57, s72, 11264
    s_and_b32 s57, s57, 0x7fff
    s_lshl_b32 s56, s57, 2
    s_add_u32 s56, s56, s74
    s_add_u32 m0, s75, s57
    s_nop 0
    buffer_load_dwordx4 v5, s[16:19], s56 offen  lds
    s_waitcnt vmcnt(4)
    s_add_u32 s57, s72, 12288
    s_and_b32 s57, s57, 0x7fff
    s_lshl_b32 s56, s57, 2
    s_add_u32 s56, s56, s74
    s_add_u32 m0, s75, s57
    s_nop 0
    buffer_load_dwordx4 v4, s[16:19], s56 offen  lds
    s_waitcnt vmcnt(4)
    s_add_u32 s57, s72, 13312
    s_and_b32 s57, s57, 0x7fff
    s_lshl_b32 s56, s57, 2
    s_add_u32 s56, s56, s74
    s_add_u32 m0, s75, s57
    s_nop 0
    buffer_load_dwordx4 v4, s[16:19], s56 offen  lds
    s_waitcnt vmcnt(4)
    s_add_u32 s57, s72, 14336
    s_and_b32 s57, s57, 0x7fff
    s_lshl_b32 s56, s57, 2
    s_add_u32 s56, s56, s74
    s_add_u32 m0, s75, s57
    s_nop 0
    buffer_load_dwordx4 v5, s[16:19], s56 offen  lds
    s_waitcnt vmcnt(4)
    s_add_u32 s57, s72, 15360
    s_and_b32 s57, s57, 0x7fff
    s_lshl_b32 s56, s57, 2
    s_add_u32 s56, s56, s74
    s_add_u32 m0, s75, s57
    s_nop 0
    buffer_load_dwordx4 v5, s[16:19], s56 offen  lds
    s_waitcnt vmcnt(4)
    s_add_u32 s57, s72, 16384
    s_and_b32 s57, s57, 0x7fff
    s_lshl_b32 s56, s57, 2
    s_add_u32 s56, s56, s74
    s_add_u32 m0, s75, s57
    s_nop 0
    buffer_load_dwordx4 v4, s[16:19], s56 offen  lds
    s_waitcnt vmcnt(4)
    s_add_u32 s57, s72, 17408
    s_and_b32 s57, s57, 0x7fff
    s_lshl_b32 s56, s57, 2
    s_add_u32 s56, s56, s74
    s_add_u32 m0, s75, s57
    s_nop 0
    buffer_load_dwordx4 v4, s[16:19], s56 offen  lds
    s_waitcnt vmcnt(4)
    s_add_u32 s57, s72, 18432
    s_and_b32 s57, s57, 0x7fff
    s_lshl_b32 s56, s57, 2
    s_add_u32 s56, s56, s74
    s_add_u32 m0, s75, s57
    s_nop 0
    buffer_load_dwordx4 v5, s[16:19], s56 offen  lds
    s_waitcnt vmcnt(4)
    s_add_u32 s57, s72, 19456
    s_and_b32 s57, s57, 0x7fff
    s_lshl_b32 s56, s57, 2
    s_add_u32 s56, s56, s74
    s_add_u32 m0, s75, s57
    s_nop 0
    buffer_load_dwordx4 v5, s[16:19], s56 offen  lds
    s_waitcnt vmcnt(4)
    s_add_u32 s57, s72, 20480
    s_and_b32 s57, s57, 0x7fff
    s_lshl_b32 s56, s57, 2
    s_add_u32 s56, s56, s74
    s_add_u32 m0, s75, s57
    s_nop 0
    buffer_load_dwordx4 v4, s[16:19], s56 offen  lds
    s_waitcnt vmcnt(4)
    s_add_u32 s57, s72, 21504
    s_and_b32 s57, s57, 0x7fff
    s_lshl_b32 s56, s57, 2
    s_add_u32 s56, s56, s74
    s_add_u32 m0, s75, s57
    s_nop 0
    buffer_load_dwordx4 v4, s[16:19], s56 offen  lds
    s_waitcnt vmcnt(4)
    s_add_u32 s57, s72, 22528
    s_and_b32 s57, s57, 0x7fff
    s_lshl_b32 s56, s57, 2
    s_add_u32 s56, s56, s74
    s_add_u32 m0, s75, s57
    s_nop 0
    buffer_load_dwordx4 v5, s[16:19], s56 offen  lds
    s_cmp_lg_u32 s49, 0
    s_cbranch_scc1 L_nml
    s_mov_b32 s57, 262144
L_gate4:
    ds_read_b32 v8, v6 offset:16
    s_waitcnt lgkmcnt(0)
    v_readfirstlane_b32 s56, v8
    s_cmp_eq_u32 s56, 8
    s_cbranch_scc1 L_gate4x
    s_sleep 2
    s_sub_u32 s57, s57, 1
    s_cbranch_scc0 L_gate4
L_gate4x:
    v_and_b32 v9, 7, v0
    v_lshlrev_b32 v9, 3, v9
    v_add_u32 v9, 163712, v9
    ds_read_b64 v[28:29], v9
    s_lshl_b32 s73, s52, 5
    s_add_u32 s73, s73, s53
    s_lshl_b32 s73, s73, 1
    s_add_u32 s73, s73, s54
    s_lshl_b32 s73, s73, 7
    s_add_u32 s73, s73, 1835008
    v_mov_b32 v33, s48
    v_mov_b32 v35, s48
    s_waitcnt lgkmcnt(0)
    v_mov_b32 v32, v28
    s_nop 1
    v_max_f32_dpp v32, v32, v32 quad_perm:[1,0,3,2] row_mask:0xf bank_mask:0xf
    s_nop 1
    v_max_f32_dpp v32, v32, v32 quad_perm:[2,3,0,1] row_mask:0xf bank_mask:0xf
    s_nop 1
    v_max_f32_dpp v32, v32, v32 row_half_mirror row_mask:0xf bank_mask:0xf
    v_sub_f32 v34, v28, v32
    v_exp_f32 v34, v34
    s_nop 0
    v_mul_f32 v34, v34, v29
    s_nop 1
    v_add_f32_dpp v34, v34, v34 quad_perm:[1,0,3,2] row_mask:0xf bank_mask:0xf
    s_nop 1
    v_add_f32_dpp v34, v34, v34 quad_perm:[2,3,0,1] row_mask:0xf bank_mask:0xf
    s_nop 1
    v_add_f32_dpp v34, v34, v34 row_half_mirror row_mask:0xf bank_mask:0xf
    s_mov_b64 exec, 0xff
    buffer_store_dwordx4 v[32:35], v11, s[44:47], s73 offen sc1
    s_mov_b64 exec, -1
    s_xor_b32 s73, s73, 128
L_nml:
    s_waitcnt vmcnt(4)
    s_add_u32 s57, s72, 23552
    s_and_b32 s57, s57, 0x7fff
    s_lshl_b32 s56, s57, 2
    s_add_u32 s56, s56, s74
    s_add_u32 m0, s75, s57
    s_nop 0
    buffer_load_dwordx4 v5, s[16:19], s56 offen  lds
    s_waitcnt vmcnt(4)
    s_add_u32 s57, s72, 24576
    s_and_b32 s57, s57, 0x7fff
    s_lshl_b32 s56, s57, 2
    s_add_u32 s56, s56, s74
    s_add_u32 m0, s75, s57
    s_nop 0
    buffer_load_dwordx4 v4, s[16:19], s56 offen  lds
    s_waitcnt vmcnt(4)
    s_add_u32 s57, s72, 25600
    s_and_b32 s57, s57, 0x7fff
    s_lshl_b32 s56, s57, 2
    s_add_u32 s56, s56, s74
    s_add_u32 m0, s75, s57
    s_nop 0
    buffer_load_dwordx4 v4, s[16:19], s56 offen  lds
    s_waitcnt vmcnt(4)
    s_add_u32 s57, s72, 26624
    s_and_b32 s57, s57, 0x7fff
    s_lshl_b32 s56, s57, 2
    s_add_u32 s56, s56, s74
    s_add_u32 m0, s75, s57
    s_nop 0
    buffer_load_dwordx4 v5, s[16:19], s56 offen  lds
    s_waitcnt vmcnt(4)
    s_add_u32 s57, s72, 27648
    s_and_b32 s57, s57, 0x7fff
    s_lshl_b32 s56, s57, 2
    s_add_u32 s56, s56, s74
    s_add_u32 m0, s75, s57
    s_nop 0
    buffer_load_dwordx4 v5, s[16:19], s56 offen  lds
    s_waitcnt vmcnt(4)
    s_add_u32 s57, s72, 28672
    s_and_b32 s57, s57, 0x7fff
    s_lshl_b32 s56, s57, 2
    s_add_u32 s56, s56, s74
    s_add_u32 m0, s75, s57
    s_nop 0
    buffer_load_dwordx4 v4, s[16:19], s56 offen  lds
    s_waitcnt vmcnt(4)
    s_add_u32 s57, s72, 29696
    s_and_b32 s57, s57, 0x7fff
    s_lshl_b32 s56, s57, 2
    s_add_u32 s56, s56, s74
    s_add_u32 m0, s75, s57
    s_nop 0
    buffer_load_dwordx4 v4, s[16:19], s56 offen  lds
    s_waitcnt vmcnt(4)
    s_add_u32 s57, s72, 30720
    s_and_b32 s57, s57, 0x7fff
    s_lshl_b32 s56, s57, 2
    s_add_u32 s56, s56, s74
    s_add_u32 m0, s75, s57
    s_nop 0
    buffer_load_dwordx4 v5, s[16:19], s56 offen  lds
    s_waitcnt vmcnt(4)
    s_add_u32 s57, s72, 31744
    s_and_b32 s57, s57, 0x7fff
    s_lshl_b32 s56, s57, 2
    s_add_u32 s56, s56, s74
    s_add_u32 m0, s75, s57
    s_nop 0
    buffer_load_dwordx4 v5, s[16:19], s56 offen  lds
    s_waitcnt vmcnt(0)
    v_bfe_u32 v8, v0, 2, 2
    v_and_b32 v9, 1, v2
    v_lshl_add_u32 v9, v9, 2, v8
    v_lshlrev_b32 v9, 5, v9
    v_lshl_add_u32 v9, v8, 8, v9
    v_lshl_add_u32 v9, v2, 11, v9
    v_and_b32 v8, 3, v0
    v_lshl_add_u32 v9, v8, 3, v9
    v_add_u32 v9, s75, v9
    v_xor_b32 v8, 0, v9
    ds_read_b64_tr_b16 v[40:41], v8 offset:0
    ds_read_b64_tr_b16 v[42:43], v8 offset:1024
    ds_read_b64_tr_b16 v[44:45], v8 offset:8192
    ds_read_b64_tr_b16 v[46:47], v8 offset:9216
    ds_read_b64_tr_b16 v[48:49], v8 offset:16384
    ds_read_b64_tr_b16 v[50:51], v8 offset:17408
    ds_read_b64_tr_b16 v[52:53], v8 offset:24576
    ds_read_b64_tr_b16 v[54:55], v8 offset:25600
    v_xor_b32 v8, 32, v9
    ds_read_b64_tr_b16 v[56:57], v8 offset:0
    ds_read_b64_tr_b16 v[58:59], v8 offset:1024
    ds_read_b64_tr_b16 v[60:61], v8 offset:8192
    ds_read_b64_tr_b16 v[62:63], v8 offset:9216
    ds_read_b64_tr_b16 v[64:65], v8 offset:16384
    ds_read_b64_tr_b16 v[66:67], v8 offset:17408
    ds_read_b64_tr_b16 v[68:69], v8 offset:24576
    ds_read_b64_tr_b16 v[70:71], v8 offset:25600
    v_xor_b32 v8, 64, v9
    ds_read_b64_tr_b16 v[72:73], v8 offset:0
    ds_read_b64_tr_b16 v[74:75], v8 offset:1024
    ds_read_b64_tr_b16 v[76:77], v8 offset:8192
    ds_read_b64_tr_b16 v[78:79], v8 offset:9216
    ds_read_b64_tr_b16 v[80:81], v8 offset:16384
    ds_read_b64_tr_b16 v[82:83], v8 offset:17408
    ds_read_b64_tr_b16 v[84:85], v8 offset:24576
    ds_read_b64_tr_b16 v[86:87], v8 offset:25600
    v_xor_b32 v8, 96, v9
    ds_read_b64_tr_b16 v[88:89], v8 offset:0
    ds_read_b64_tr_b16 v[90:91], v8 offset:1024
    ds_read_b64_tr_b16 v[92:93], v8 offset:8192
    ds_read_b64_tr_b16 v[94:95], v8 offset:9216
    ds_read_b64_tr_b16 v[96:97], v8 offset:16384
    ds_read_b64_tr_b16 v[98:99], v8 offset:17408
    ds_read_b64_tr_b16 v[100:101], v8 offset:24576
    ds_read_b64_tr_b16 v[102:103], v8 offset:25600
    v_xor_b32 v8, 128, v9
    ds_read_b64_tr_b16 v[104:105], v8 offset:0
    ds_read_b64_tr_b16 v[106:107], v8 offset:1024
    ds_read_b64_tr_b16 v[108:109], v8 offset:8192
    ds_read_b64_tr_b16 v[110:111], v8 offset:9216
    ds_read_b64_tr_b16 v[112:113], v8 offset:16384
    ds_read_b64_tr_b16 v[114:115], v8 offset:17408
    ds_read_b64_tr_b16 v[116:117], v8 offset:24576
    ds_read_b64_tr_b16 v[118:119], v8 offset:25600
    v_xor_b32 v8, 160, v9
    ds_read_b64_tr_b16 v[120:121], v8 offset:0
    ds_read_b64_tr_b16 v[122:123], v8 offset:1024
    ds_read_b64_tr_b16 v[124:125], v8 offset:8192
    ds_read_b64_tr_b16 v[126:127], v8 offset:9216
    ds_read_b64_tr_b16 v[128:129], v8 offset:16384
    ds_read_b64_tr_b16 v[130:131], v8 offset:17408
    ds_read_b64_tr_b16 v[132:133], v8 offset:24576
    ds_read_b64_tr_b16 v[134:135], v8 offset:25600
    v_xor_b32 v8, 192, v9
    ds_read_b64_tr_b16 v[136:137], v8 offset:0
    ds_read_b64_tr_b16 v[138:139], v8 offset:1024
    ds_read_b64_tr_b16 v[140:141], v8 offset:8192
    ds_read_b64_tr_b16 v[142:143], v8 offset:9216
    ds_read_b64_tr_b16 v[144:145], v8 offset:16384
    ds_read_b64_tr_b16 v[146:147], v8 offset:17408
    ds_read_b64_tr_b16 v[148:149], v8 offset:24576
    ds_read_b64_tr_b16 v[150:151], v8 offset:25600
    v_xor_b32 v8, 224, v9
    ds_read_b64_tr_b16 v[152:153], v8 offset:0
    ds_read_b64_tr_b16 v[154:155], v8 offset:1024
    ds_read_b64_tr_b16 v[156:157], v8 offset:8192
    ds_read_b64_tr_b16 v[158:159], v8 offset:9216
    ds_read_b64_tr_b16 v[160:161], v8 offset:16384
    ds_read_b64_tr_b16 v[162:163], v8 offset:17408
    ds_read_b64_tr_b16 v[164:165], v8 offset:24576
    ds_read_b64_tr_b16 v[166:167], v8 offset:25600
    v_and_b32 v4, 7, v0
    v_mul_u32_u24 v4, 272, v4
    v_lshl_add_u32 v4, v2, 4, v4
    v_add_u32 v4, 157696, v4
    v_lshlrev_b32 v5, 13, v2
    v_lshl_add_u32 v5, v3, 3, v5
    s_lshl_b32 s55, s52, 17
    s_lshl_b32 s56, s49, 15
    s_add_u32 s55, s55, s56
    s_lshl_b32 s56, s53, 8
    s_add_u32 s55, s55, s56
    s_lshl_b32 s56, s54, 7
    s_add_u32 s55, s55, s56
    s_add_u32 s55, s55, 262144
    v_mov_b32 v7, s48
    s_waitcnt lgkmcnt(0)
    s_cmp_lg_u32 s49, 0
    s_cbranch_scc1 L_nml2
    s_mov_b32 s57, 262144
L_gate5:
    ds_read_b32 v8, v6 offset:20
    s_waitcnt lgkmcnt(0)
    v_readfirstlane_b32 s56, v8
    s_cmp_lg_u32 s56, 0
    s_cbranch_scc1 L_gate5x
    s_sleep 2
    s_sub_u32 s57, s57, 1
    s_cbranch_scc0 L_gate5
L_gate5x:
    v_mov_b32 v9, 0
    s_mov_b64 s[58:59], -1
    s_mov_b32 s57, 32768
L_g5:
    s_mov_b64 exec, s[58:59]
    s_cbranch_execz L_g5_0
    buffer_load_dwordx4 v[12:15], v9, s[44:47], s73 offen offset:0 sc1
L_g5_0:
    s_waitcnt vmcnt(0)
    s_mov_b64 exec, s[58:59]
    v_cmp_ne_u32 s[58:59], s48, v13
    v_cmp_ne_u32 vcc, s48, v15
    s_or_b64 s[58:59], s[58:59], vcc
    s_or_b64 s[100:101], s[58:59], s[58:59]
    s_cbranch_scc0 L_g5_x
    s_sleep 4
    s_sub_u32 s57, s57, 1
    s_cbranch_scc0 L_g5
L_g5_x:
    s_mov_b64 exec, -1
    v_max_f32 v8, v32, v12
    v_sub_f32 v32, v32, v8
    v_sub_f32 v12, v12, v8
    v_sub_f32 v28, v28, v8
    v_exp_f32 v32, v32
    v_exp_f32 v12, v12
    v_exp_f32 v28, v28
    v_and_b32 v9, 7, v0
    v_mul_f32 v34, v34, v32
    v_fmac_f32 v34, v14, v12
    v_rcp_f32 v34, v34
    v_lshlrev_b32 v9, 2, v9
    v_add_u32 v9, 163776, v9
    v_mul_f32 v28, v28, v34
    ds_write_b32 v9, v28
    s_waitcnt lgkmcnt(0)
L_nml2:
    v_and_b32 v6, 1, v2
    v_lshlrev_b32 v6, 4, v6
    v_add_u32 v6, 163776, v6
    s_cmp_ge_u32 s2, 200
    s_cbranch_scc1 L_t2
    s_sub_u32 s56, s2, 64
    s_cmp_lt_u32 s56, 32
    s_cbranch_scc1 L_t3
    s_lshl_b32 s3, s2, 1
    s_add_u32 s3, s3, s49
    s_and_b32 s3, s3, 127
    v_lshrrev_b32 v28, 2, v1
    v_lshlrev_b32 v28, 7, v28
    v_and_b32 v29, 3, v0
    v_lshl_add_u32 v28, v29, 4, v28
    v_and_b32 v31, 1, v2
    v_lshlrev_b32 v30, 2, v29
    v_lshl_add_u32 v30, v31, 7, v30
    v_lshlrev_b32 v29, 3, v29
    v_lshl_add_u32 v29, v31, 10, v29
    v_lshlrev_b32 v31, 6, v31
    v_lshl_add_u32 v31, v3, 3, v31
    s_and_b32 s75, s3, 7
    s_lshl_b32 s75, s75, 4
    s_lshr_b32 s56, s3, 3
    s_lshl_b32 s56, s56, 8
    s_add_u32 s75, s75, s56
    s_lshr_b32 s74, s3, 5
    s_lshl_b32 s74, s74, 6
    s_bfe_u32 s56, s3, 0x20003
    s_lshl_b32 s56, s56, 11
    s_add_u32 s74, s74, s56
    s_bfe_u32 s56, s3, 0x20001
    s_lshl_b32 s56, s56, 8
    s_add_u32 s74, s74, s56
    s_and_b32 s56, s3, 1
    s_lshl_b32 s57, s56, 5
    s_add_u32 s74, s74, s57
    s_add_u32 s74, s74, 20480
    s_lshl_b32 s56, s56, 6
    s_lshr_b32 s72, s3, 1
    s_lshl_b32 s72, s72, 13
    s_add_u32 s72, s72, s56
    s_add_u32 s72, s72, 262144
    s_add_u32 s73, s72, 4096
    s_lshl_b32 s3, s3, 7
    s_add_u32 s3, s3, 131072
    s_barrier
    ds_read_b128 v[8:11], v4 offset:0
    ds_read_b128 v[12:15], v4 offset:64
    ds_read_b128 v[16:19], v4 offset:128
    ds_read_b128 v[20:23], v4 offset:192
    ds_read_b128 v[32:35], v6
    s_waitcnt lgkmcnt(4)
    v_mfma_f32_16x16x32_bf16 v[24:27], v[8:11], v[40:43], 0
    s_waitcnt lgkmcnt(3)
    v_mfma_f32_16x16x32_bf16 v[24:27], v[12:15], v[44:47], v[24:27]
    s_waitcnt lgkmcnt(2)
    v_mfma_f32_16x16x32_bf16 v[24:27], v[16:19], v[48:51], v[24:27]
    s_waitcnt lgkmcnt(1)
    v_mfma_f32_16x16x32_bf16 v[24:27], v[20:23], v[52:55], v[24:27]
    s_waitcnt lgkmcnt(0)
    v_mfma_f32_16x16x32_bf16 v[40:43], v[8:11], v[56:59], 0
    v_mfma_f32_16x16x32_bf16 v[40:43], v[12:15], v[60:63], v[40:43]
    v_mfma_f32_16x16x32_bf16 v[40:43], v[16:19], v[64:67], v[40:43]
    v_mfma_f32_16x16x32_bf16 v[40:43], v[20:23], v[68:71], v[40:43]
    v_mfma_f32_16x16x32_bf16 v[56:59], v[8:11], v[72:75], 0
    v_mfma_f32_16x16x32_bf16 v[56:59], v[12:15], v[76:79], v[56:59]
    v_mfma_f32_16x16x32_bf16 v[56:59], v[16:19], v[80:83], v[56:59]
    v_mfma_f32_16x16x32_bf16 v[56:59], v[20:23], v[84:87], v[56:59]
    v_mfma_f32_16x16x32_bf16 v[72:75], v[8:11], v[88:91], 0
    v_mfma_f32_16x16x32_bf16 v[72:75], v[12:15], v[92:95], v[72:75]
    v_mfma_f32_16x16x32_bf16 v[72:75], v[16:19], v[96:99], v[72:75]
    v_mfma_f32_16x16x32_bf16 v[72:75], v[20:23], v[100:103], v[72:75]
    v_mfma_f32_16x16x32_bf16 v[88:91], v[8:11], v[104:107], 0
    v_mfma_f32_16x16x32_bf16 v[88:91], v[12:15], v[108:111], v[88:91]
    v_mfma_f32_16x16x32_bf16 v[88:91], v[16:19], v[112:115], v[88:91]
    v_mfma_f32_16x16x32_bf16 v[88:91], v[20:23], v[116:119], v[88:91]
    v_mfma_f32_16x16x32_bf16 v[104:107], v[8:11], v[120:123], 0
    v_mfma_f32_16x16x32_bf16 v[104:107], v[12:15], v[124:127], v[104:107]
    v_pk_mul_f32 v[24:25], v[24:25], v[32:33]
    v_pk_mul_f32 v[40:41], v[40:41], v[32:33]
    v_mfma_f32_16x16x32_bf16 v[104:107], v[16:19], v[128:131], v[104:107]
    v_pk_mul_f32 v[56:57], v[56:57], v[32:33]
    v_pk_mul_f32 v[72:73], v[72:73], v[32:33]
    v_mfma_f32_16x16x32_bf16 v[104:107], v[20:23], v[132:135], v[104:107]
    v_pk_fma_f32 v[24:25], v[26:27], v[34:35], v[24:25]
    v_pk_fma_f32 v[40:41], v[42:43], v[34:35], v[40:41]
    v_mfma_f32_16x16x32_bf16 v[120:123], v[8:11], v[136:139], 0
    v_pk_fma_f32 v[56:57], v[58:59], v[34:35], v[56:57]
    v_pk_fma_f32 v[72:73], v[74:75], v[34:35], v[72:73]
    v_mfma_f32_16x16x32_bf16 v[120:123], v[12:15], v[140:143], v[120:123]
    v_add_f32 v24, v24, v25
    v_add_f32 v40, v40, v41
    v_mfma_f32_16x16x32_bf16 v[120:123], v[16:19], v[144:147], v[120:123]
    v_add_f32 v56, v56, v57
    v_add_f32 v72, v72, v73
    v_mfma_f32_16x16x32_bf16 v[120:123], v[20:23], v[148:151], v[120:123]
    v_permlane16_swap_b32 v24, v40
    v_permlane16_swap_b32 v56, v72
    v_mfma_f32_16x16x32_bf16 v[136:139], v[8:11], v[152:155], 0
    v_add_f32 v24, v24, v40
    v_add_f32 v56, v56, v72
    v_mfma_f32_16x16x32_bf16 v[136:139], v[12:15], v[156:159], v[136:139]
    s_nop 0
    v_permlane32_swap_b32 v24, v56
    v_mfma_f32_16x16x32_bf16 v[136:139], v[16:19], v[160:163], v[136:139]
    v_mfma_f32_16x16x32_bf16 v[136:139], v[20:23], v[164:167], v[136:139]
    v_pk_mul_f32 v[88:89], v[88:89], v[32:33]
    v_pk_mul_f32 v[104:105], v[104:105], v[32:33]
    v_pk_mul_f32 v[120:121], v[120:121], v[32:33]
    s_nop 4
    v_pk_mul_f32 v[136:137], v[136:137], v[32:33]
    v_pk_fma_f32 v[88:89], v[90:91], v[34:35], v[88:89]
    v_pk_fma_f32 v[104:105], v[106:107], v[34:35], v[104:105]
    v_pk_fma_f32 v[120:121], v[122:123], v[34:35], v[120:121]
    v_pk_fma_f32 v[136:137], v[138:139], v[34:35], v[136:137]
    v_add_f32 v88, v88, v89
    v_add_f32 v104, v104, v105
    v_add_f32 v120, v120, v121
    v_add_f32 v136, v136, v137
    v_permlane16_swap_b32 v88, v104
    s_nop 0
    v_permlane16_swap_b32 v120, v136
    v_add_f32 v88, v88, v104
    v_add_f32 v120, v120, v136
    s_nop 1
    v_permlane32_swap_b32 v88, v120
    v_cvt_pk_bf16_f32 v6, v24, v88
    buffer_store_dwordx2 v[6:7], v5, s[44:47], s55 offen sc1
    s_cmp_ge_u32 s2, 64
    s_cbranch_scc1 L_done
    s_cmp_ge_u32 s49, 2
    s_cbranch_scc1 L_done
    buffer_load_dword v15, v30, s[28:31], s75 offen
    s_mov_b64 s[58:59], -1
    s_mov_b32 s57, 32768
L_g6:
    s_mov_b64 exec, s[58:59]
    s_cbranch_execz L_g6_0
    buffer_load_dwordx2 v[16:17], v29, s[44:47], s74 offen offset:0 sc1
L_g6_0:
    s_waitcnt vmcnt(0)
    s_mov_b64 exec, s[58:59]
    v_cmp_ne_u32 s[58:59], s48, v17
    s_or_b64 s[100:101], s[58:59], s[58:59]
    s_cbranch_scc0 L_g6_x
    s_sub_u32 s57, s57, 1
    s_cbranch_scc0 L_g6
L_g6_x:
    s_mov_b64 exec, -1
    v_lshlrev_b32 v32, 16, v15
    v_and_b32 v33, 0xffff0000, v15
    v_lshlrev_b32 v34, 16, v16
    v_and_b32 v35, 0xffff0000, v16
    s_mov_b32 s57, 32768
L_g7:
    buffer_load_dwordx4 v[104:107], v28, s[44:47], s72 offen offset:0 sc1
    buffer_load_dwordx4 v[108:111], v28, s[44:47], s72 offen offset:2048 sc1
    buffer_load_dwordx4 v[112:115], v28, s[44:47], s73 offen offset:0 sc1
    buffer_load_dwordx4 v[116:119], v28, s[44:47], s73 offen offset:2048 sc1
L_g7_w:
    s_waitcnt vmcnt(3)
    v_bitop3_b32 v105, v105, v107, s48 bitop3:0x7e
    s_waitcnt vmcnt(2)
    v_bitop3_b32 v109, v109, v111, s48 bitop3:0x7e
    s_waitcnt vmcnt(1)
    v_bitop3_b32 v113, v113, v115, s48 bitop3:0x7e
    v_or3_b32 v105, v105, v109, v113
    s_waitcnt vmcnt(0)
    v_bitop3_b32 v117, v117, v119, s48 bitop3:0x7e
    v_or_b32 v105, v105, v117
    v_cmp_ne_u32 vcc, 0, v105
    s_and_b64 exec, vcc, vcc
    s_cbranch_scc0 L_g7_x
    s_sub_u32 s57, s57, 1
    s_cbranch_scc0 L_g7
L_g7_x:
    s_mov_b64 exec, -1
    v_and_b32 v105, 0xffff0000, v104
    v_and_b32 v107, 0xffff0000, v106
    v_lshlrev_b32 v104, 16, v104
    v_lshlrev_b32 v106, 16, v106
    v_and_b32 v109, 0xffff0000, v108
    v_and_b32 v111, 0xffff0000, v110
    v_lshlrev_b32 v108, 16, v108
    v_lshlrev_b32 v110, 16, v110
    v_and_b32 v113, 0xffff0000, v112
    v_and_b32 v115, 0xffff0000, v114
    v_lshlrev_b32 v112, 16, v112
    v_lshlrev_b32 v114, 16, v114
    v_and_b32 v117, 0xffff0000, v116
    v_and_b32 v119, 0xffff0000, v118
    v_lshlrev_b32 v116, 16, v116
    v_lshlrev_b32 v118, 16, v118
    v_pk_add_f32 v[104:105], v[104:105], v[108:109]
    v_pk_add_f32 v[106:107], v[106:107], v[110:111]
    v_pk_add_f32 v[112:113], v[112:113], v[116:117]
    v_pk_add_f32 v[114:115], v[114:115], v[118:119]
    v_pk_add_f32 v[104:105], v[104:105], v[112:113]
    v_pk_add_f32 v[106:107], v[106:107], v[114:115]
    s_nop 0
    v_permlane16_swap_b32 v104, v105
    v_permlane16_swap_b32 v106, v107
    v_add_f32 v104, v104, v105
    v_add_f32 v106, v106, v107
    v_mov_b32 v105, v104
    v_mov_b32 v107, v106
    s_nop 0
    v_permlane32_swap_b32 v104, v105
    v_permlane32_swap_b32 v106, v107
    v_add_f32 v104, v104, v105
    v_add_f32 v106, v106, v107
    s_nop 0
    v_add_f32_dpp v104, v104, v104 row_ror:4 row_mask:0xf bank_mask:0xf
    v_add_f32_dpp v106, v106, v106 row_ror:4 row_mask:0xf bank_mask:0xf
    s_nop 0
    v_add_f32_dpp v104, v104, v104 row_ror:8 row_mask:0xf bank_mask:0xf
    v_add_f32_dpp v106, v106, v106 row_ror:8 row_mask:0xf bank_mask:0xf
    v_fmac_f32 v32, v34, v104
    v_fmac_f32 v33, v35, v106
    v_cvt_pk_bf16_f32 v6, v32, v33
    s_mov_b64 exec, 0xff00ff
    buffer_store_dwordx2 v[6:7], v31, s[44:47], s3 offen sc1
    s_mov_b64 exec, -1
    s_branch L_done
L_t2:
    s_mul_i32 s3, s50, 7
    s_add_u32 s3, s3, s51
    s_sub_u32 s3, s3, 25
    v_lshrrev_b32 v30, 2, v1
    v_and_b32 v28, 3, v0
    v_lshlrev_b32 v28, 4, v28
    v_lshl_add_u32 v31, v30, 8, v28
    v_and_b32 v28, 1, v0
    v_lshlrev_b32 v28, 4, v28
    v_bfe_u32 v30, v0, 1, 3
    v_lshl_add_u32 v28, v30, 7, v28
    v_and_b32 v30, 1, v2
    v_lshl_add_u32 v28, v30, 6, v28
    v_lshrrev_b32 v30, 1, v2
    v_lshl_add_u32 v28, v30, 10, v28
    s_lshl_b32 s66, s49, 6
    s_add_u32 s66, s66, 28672
    s_add_u32 s67, s66, 4096
    s_add_u32 s68, s66, 8192
    s_add_u32 s69, s66, 12288
    v_lshrrev_b32 v29, 2, v1
    v_and_b32 v9, 3, v0
    v_lshlrev_b32 v9, 4, v9
    v_mul_u32_u24 v29, 3584, v29
    v_add_u32 v29, v29, v9
    v_lshlrev_b32 v30, 10, v2
    v_lshl_add_u32 v30, v3, 4, v30
    s_mul_i32 s74, s49, 458752
    s_lshl_b32 s56, s3, 6
    s_add_u32 s74, s74, s56
    s_lshl_b32 s70, s49, 12
    s_add_u32 s70, s70, 131072
    s_lshl_b32 s72, s3, 15
    s_lshl_b32 s56, s49, 8
    s_add_u32 s72, s72, s56
    s_mul_i32 s73, s49, 114688
    s_lshl_b32 s56, s3, 7
    s_add_u32 s73, s73, s56
    s_add_u32 s73, s73, 4194304
    s_add_u32 s3, s73, 57344
    s_barrier
    ds_read_b128 v[8:11], v4 offset:0
    ds_read_b128 v[12:15], v4 offset:64
    ds_read_b128 v[16:19], v4 offset:128
    ds_read_b128 v[20:23], v4 offset:192
    ds_read_b128 v[32:35], v6
    s_waitcnt lgkmcnt(4)
    v_mfma_f32_16x16x32_bf16 v[24:27], v[8:11], v[40:43], 0
    s_waitcnt lgkmcnt(3)
    v_mfma_f32_16x16x32_bf16 v[24:27], v[12:15], v[44:47], v[24:27]
    s_waitcnt lgkmcnt(2)
    v_mfma_f32_16x16x32_bf16 v[24:27], v[16:19], v[48:51], v[24:27]
    s_waitcnt lgkmcnt(1)
    v_mfma_f32_16x16x32_bf16 v[24:27], v[20:23], v[52:55], v[24:27]
    s_add_u32 s56, s74, 0
    s_add_u32 m0, s75, 0
    s_nop 0
    buffer_load_dwordx4 v29, s[20:23], s56 offen  lds
    s_waitcnt lgkmcnt(0)
    v_mfma_f32_16x16x32_bf16 v[40:43], v[8:11], v[56:59], 0
    v_mfma_f32_16x16x32_bf16 v[40:43], v[12:15], v[60:63], v[40:43]
    v_mfma_f32_16x16x32_bf16 v[40:43], v[16:19], v[64:67], v[40:43]
    v_mfma_f32_16x16x32_bf16 v[40:43], v[20:23], v[68:71], v[40:43]
    s_add_u32 s56, s74, 57344
    s_add_u32 m0, s75, 1024
    s_nop 0
    buffer_load_dwordx4 v29, s[20:23], s56 offen  lds
    v_mfma_f32_16x16x32_bf16 v[56:59], v[8:11], v[72:75], 0
    v_mfma_f32_16x16x32_bf16 v[56:59], v[12:15], v[76:79], v[56:59]
    v_mfma_f32_16x16x32_bf16 v[56:59], v[16:19], v[80:83], v[56:59]
    v_mfma_f32_16x16x32_bf16 v[56:59], v[20:23], v[84:87], v[56:59]
    s_add_u32 s56, s74, 114688
    s_add_u32 m0, s75, 2048
    s_nop 0
    buffer_load_dwordx4 v29, s[20:23], s56 offen  lds
    v_mfma_f32_16x16x32_bf16 v[72:75], v[8:11], v[88:91], 0
    v_mfma_f32_16x16x32_bf16 v[72:75], v[12:15], v[92:95], v[72:75]
    v_mfma_f32_16x16x32_bf16 v[72:75], v[16:19], v[96:99], v[72:75]
    v_mfma_f32_16x16x32_bf16 v[72:75], v[20:23], v[100:103], v[72:75]
    s_add_u32 s56, s74, 172032
    s_add_u32 m0, s75, 3072
    s_nop 0
    buffer_load_dwordx4 v29, s[20:23], s56 offen  lds
    v_mfma_f32_16x16x32_bf16 v[88:91], v[8:11], v[104:107], 0
    v_mfma_f32_16x16x32_bf16 v[88:91], v[12:15], v[108:111], v[88:91]
    v_mfma_f32_16x16x32_bf16 v[88:91], v[16:19], v[112:115], v[88:91]
    v_mfma_f32_16x16x32_bf16 v[88:91], v[20:23], v[116:119], v[88:91]
    v_mfma_f32_16x16x32_bf16 v[104:107], v[8:11], v[120:123], 0
    v_mfma_f32_16x16x32_bf16 v[104:107], v[12:15], v[124:127], v[104:107]
    v_pk_mul_f32 v[24:25], v[24:25], v[32:33]
    v_pk_mul_f32 v[40:41], v[40:41], v[32:33]
    v_mfma_f32_16x16x32_bf16 v[104:107], v[16:19], v[128:131], v[104:107]
    v_pk_mul_f32 v[56:57], v[56:57], v[32:33]
    v_pk_mul_f32 v[72:73], v[72:73], v[32:33]
    v_mfma_f32_16x16x32_bf16 v[104:107], v[20:23], v[132:135], v[104:107]
    v_pk_fma_f32 v[24:25], v[26:27], v[34:35], v[24:25]
    v_pk_fma_f32 v[40:41], v[42:43], v[34:35], v[40:41]
    v_mfma_f32_16x16x32_bf16 v[120:123], v[8:11], v[136:139], 0
    v_pk_fma_f32 v[56:57], v[58:59], v[34:35], v[56:57]
    v_pk_fma_f32 v[72:73], v[74:75], v[34:35], v[72:73]
    v_mfma_f32_16x16x32_bf16 v[120:123], v[12:15], v[140:143], v[120:123]
    v_add_f32 v24, v24, v25
    v_add_f32 v40, v40, v41
    v_mfma_f32_16x16x32_bf16 v[120:123], v[16:19], v[144:147], v[120:123]
    v_add_f32 v56, v56, v57
    v_add_f32 v72, v72, v73
    v_mfma_f32_16x16x32_bf16 v[120:123], v[20:23], v[148:151], v[120:123]
    v_permlane16_swap_b32 v24, v40
    v_permlane16_swap_b32 v56, v72
    v_mfma_f32_16x16x32_bf16 v[136:139], v[8:11], v[152:155], 0
    v_add_f32 v24, v24, v40
    v_add_f32 v56, v56, v72
    v_mfma_f32_16x16x32_bf16 v[136:139], v[12:15], v[156:159], v[136:139]
    s_nop 0
    v_permlane32_swap_b32 v24, v56
    v_mfma_f32_16x16x32_bf16 v[136:139], v[16:19], v[160:163], v[136:139]
    v_mfma_f32_16x16x32_bf16 v[136:139], v[20:23], v[164:167], v[136:139]
    v_pk_mul_f32 v[88:89], v[88:89], v[32:33]
    v_pk_mul_f32 v[104:105], v[104:105], v[32:33]
    v_pk_mul_f32 v[120:121], v[120:121], v[32:33]
    s_nop 4
    v_pk_mul_f32 v[136:137], v[136:137], v[32:33]
    v_pk_fma_f32 v[88:89], v[90:91], v[34:35], v[88:89]
    v_pk_fma_f32 v[104:105], v[106:107], v[34:35], v[104:105]
    v_pk_fma_f32 v[120:121], v[122:123], v[34:35], v[120:121]
    v_pk_fma_f32 v[136:137], v[138:139], v[34:35], v[136:137]
    v_add_f32 v88, v88, v89
    v_add_f32 v104, v104, v105
    v_add_f32 v120, v120, v121
    v_add_f32 v136, v136, v137
    v_permlane16_swap_b32 v88, v104
    s_nop 0
    v_permlane16_swap_b32 v120, v136
    v_add_f32 v88, v88, v104
    v_add_f32 v120, v120, v136
    s_nop 1
    v_permlane32_swap_b32 v88, v120
    v_cvt_pk_bf16_f32 v6, v24, v88
    buffer_store_dwordx2 v[6:7], v5, s[44:47], s55 offen sc1
    s_add_u32 s56, s74, 229376
    s_add_u32 m0, s75, 4096
    s_nop 0
    buffer_load_dwordx4 v29, s[20:23], s56 offen  lds
    s_add_u32 s56, s74, 286720
    s_add_u32 m0, s75, 5120
    s_nop 0
    buffer_load_dwordx4 v29, s[20:23], s56 offen  lds
    s_add_u32 s56, s74, 344064
    s_add_u32 m0, s75, 6144
    s_nop 0
    buffer_load_dwordx4 v29, s[20:23], s56 offen  lds
    s_add_u32 s56, s74, 401408
    s_add_u32 m0, s75, 7168
    s_nop 0
    buffer_load_dwordx4 v29, s[20:23], s56 offen  lds
    s_add_u32 s56, s72, 0
    s_add_u32 m0, s75, 8192
    s_nop 0
    buffer_load_dwordx4 v30, s[24:27], s56 offen  lds
    s_add_u32 s56, s72, 4096
    s_add_u32 m0, s75, 9216
    s_nop 0
    buffer_load_dwordx4 v30, s[24:27], s56 offen  lds
    s_add_u32 s56, s72, 8192
    s_add_u32 m0, s75, 10240
    s_nop 0
    buffer_load_dwordx4 v30, s[24:27], s56 offen  lds
    s_add_u32 s56, s72, 12288
    s_add_u32 m0, s75, 11264
    s_nop 0
    buffer_load_dwordx4 v30, s[24:27], s56 offen  lds
    s_add_u32 s56, s72, 16384
    s_add_u32 m0, s75, 12288
    s_nop 0
    buffer_load_dwordx4 v30, s[24:27], s56 offen  lds
    s_add_u32 s56, s72, 20480
    s_add_u32 m0, s75, 13312
    s_nop 0
    buffer_load_dwordx4 v30, s[24:27], s56 offen  lds
    s_add_u32 s56, s72, 24576
    s_add_u32 m0, s75, 14336
    s_nop 0
    buffer_load_dwordx4 v30, s[24:27], s56 offen  lds
    s_add_u32 s56, s72, 28672
    s_add_u32 m0, s75, 15360
    s_nop 0
    buffer_load_dwordx4 v30, s[24:27], s56 offen  lds
    buffer_load_dwordx4 v[136:139], v31, s[44:47], s66 offen sc1
    buffer_load_dwordx4 v[140:143], v31, s[44:47], s67 offen sc1
    buffer_load_dwordx4 v[144:147], v31, s[44:47], s68 offen sc1
    buffer_load_dwordx4 v[148:151], v31, s[44:47], s69 offen sc1
    buffer_load_dwordx4 v[104:107], v28, s[44:47], s70 offen offset:0 sc1
    buffer_load_dwordx4 v[108:111], v28, s[44:47], s70 offen offset:2048 sc1
    s_mul_i32 s56, s49, 1040
    s_add_u32 s56, s56, 147456
    v_lshl_add_u32 v29, v1, 3, s56
    v_and_b32 v4, 3, v0
    v_bfe_u32 v30, v0, 2, 2
    v_lshl_add_u32 v30, v30, 6, s75
    v_lshl_add_u32 v30, v2, 9, v30
    v_lshl_add_u32 v30, v4, 3, v30
    v_lshrrev_b32 v122, 2, v1
    v_lshl_add_u32 v122, v122, 8, s75
    v_lshl_add_u32 v122, v4, 3, v122
    s_waitcnt vmcnt(2)
    ds_read_b64_tr_b16 v[40:41], v30 offset:0
    ds_read_b64_tr_b16 v[42:43], v30 offset:256
    ds_read_b64_tr_b16 v[44:45], v30 offset:2048
    ds_read_b64_tr_b16 v[46:47], v30 offset:2304
    ds_read_b64_tr_b16 v[48:49], v30 offset:4096
    ds_read_b64_tr_b16 v[50:51], v30 offset:4352
    ds_read_b64_tr_b16 v[52:53], v30 offset:6144
    ds_read_b64_tr_b16 v[54:55], v30 offset:6400
    ds_read_b64_tr_b16 v[56:57], v30 offset:32
    ds_read_b64_tr_b16 v[58:59], v30 offset:288
    ds_read_b64_tr_b16 v[60:61], v30 offset:2080
    ds_read_b64_tr_b16 v[62:63], v30 offset:2336
    ds_read_b64_tr_b16 v[64:65], v30 offset:4128
    ds_read_b64_tr_b16 v[66:67], v30 offset:4384
    ds_read_b64_tr_b16 v[68:69], v30 offset:6176
    ds_read_b64_tr_b16 v[70:71], v30 offset:6432
    ds_read_b64_tr_b16 v[72:73], v122 offset:8192
    ds_read_b64_tr_b16 v[74:75], v122 offset:12288
    ds_read_b64_tr_b16 v[76:77], v122 offset:8224
    ds_read_b64_tr_b16 v[78:79], v122 offset:12320
    ds_read_b64_tr_b16 v[80:81], v122 offset:8256
    ds_read_b64_tr_b16 v[82:83], v122 offset:12352
    ds_read_b64_tr_b16 v[84:85], v122 offset:8288
    ds_read_b64_tr_b16 v[86:87], v122 offset:12384
    ds_read_b64_tr_b16 v[88:89], v122 offset:8320
    ds_read_b64_tr_b16 v[90:91], v122 offset:12416
    ds_read_b64_tr_b16 v[92:93], v122 offset:8352
    ds_read_b64_tr_b16 v[94:95], v122 offset:12448
    ds_read_b64_tr_b16 v[96:97], v122 offset:8384
    ds_read_b64_tr_b16 v[98:99], v122 offset:12480
    ds_read_b64_tr_b16 v[100:101], v122 offset:8416
    ds_read_b64_tr_b16 v[102:103], v122 offset:12512
    v_bitop3_b32 v137, v137, v139, s48 bitop3:0x7e
    v_bitop3_b32 v141, v141, v143, s48 bitop3:0x7e
    v_bitop3_b32 v145, v145, v147, s48 bitop3:0x7e
    v_bitop3_b32 v149, v149, v151, s48 bitop3:0x7e
    v_or3_b32 v137, v137, v141, v145
    v_or_b32 v137, v137, v149
    v_cmp_ne_u32 vcc, 0, v137
    s_cbranch_vccz L_t2ok
    s_mov_b64 s[58:59], -1
    s_mov_b64 s[60:61], -1
    s_mov_b64 s[62:63], -1
    s_mov_b64 s[64:65], -1
    s_mov_b32 s57, 32768
L_g9:
    s_mov_b64 exec, s[58:59]
    s_cbranch_execz L_g9_0
    buffer_load_dwordx4 v[136:139], v31, s[44:47], s66 offen offset:0 sc1
L_g9_0:
    s_mov_b64 exec, s[60:61]
    s_cbranch_execz L_g9_1
    buffer_load_dwordx4 v[140:143], v31, s[44:47], s67 offen offset:0 sc1
L_g9_1:
    s_mov_b64 exec, s[62:63]
    s_cbranch_execz L_g9_2
    buffer_load_dwordx4 v[144:147], v31, s[44:47], s68 offen offset:0 sc1
L_g9_2:
    s_mov_b64 exec, s[64:65]
    s_cbranch_execz L_g9_3
    buffer_load_dwordx4 v[148:151], v31, s[44:47], s69 offen offset:0 sc1
L_g9_3:
    s_waitcnt vmcnt(0)
    s_mov_b64 exec, s[58:59]
    v_cmp_ne_u32 s[58:59], s48, v137
    v_cmp_ne_u32 vcc, s48, v139
    s_or_b64 s[58:59], s[58:59], vcc
    s_mov_b64 exec, s[60:61]
    v_cmp_ne_u32 s[60:61], s48, v141
    v_cmp_ne_u32 vcc, s48, v143
    s_or_b64 s[60:61], s[60:61], vcc
    s_mov_b64 exec, s[62:63]
    v_cmp_ne_u32 s[62:63], s48, v145
    v_cmp_ne_u32 vcc, s48, v147
    s_or_b64 s[62:63], s[62:63], vcc
    s_mov_b64 exec, s[64:65]
    v_cmp_ne_u32 s[64:65], s48, v149
    v_cmp_ne_u32 vcc, s48, v151
    s_or_b64 s[64:65], s[64:65], vcc
    s_or_b64 s[100:101], s[58:59], s[58:59]
    s_or_b64 s[100:101], s[100:101], s[60:61]
    s_or_b64 s[100:101], s[100:101], s[62:63]
    s_or_b64 s[100:101], s[100:101], s[64:65]
    s_cbranch_scc0 L_g9_x
    s_sub_u32 s57, s57, 1
    s_cbranch_scc0 L_g9
L_g9_x:
    s_mov_b64 exec, -1
L_t2ok:
    v_lshlrev_b32 v8, 16, v136
    v_and_b32 v9, 0xffff0000, v136
    v_lshlrev_b32 v10, 16, v138
    v_and_b32 v11, 0xffff0000, v138
    v_lshlrev_b32 v12, 16, v140
    v_and_b32 v13, 0xffff0000, v140
    v_lshlrev_b32 v14, 16, v142
    v_and_b32 v15, 0xffff0000, v142
    v_lshlrev_b32 v16, 16, v144
    v_and_b32 v17, 0xffff0000, v144
    v_lshlrev_b32 v18, 16, v146
    v_and_b32 v19, 0xffff0000, v146
    v_lshlrev_b32 v20, 16, v148
    v_and_b32 v21, 0xffff0000, v148
    v_lshlrev_b32 v22, 16, v150
    v_and_b32 v23, 0xffff0000, v150
    v_add_f32 v16, 1.0, v16
    v_add_f32 v17, 1.0, v17
    v_add_f32 v18, 1.0, v18
    v_add_f32 v19, 1.0, v19
    v_add_f32 v20, 1.0, v20
    v_add_f32 v21, 1.0, v21
    v_add_f32 v22, 1.0, v22
    v_add_f32 v23, 1.0, v23
    v_mul_u32_u24 v30, 1040, v4
    v_lshl_add_u32 v30, v2, 4, v30
    s_lshl_b32 s56, s49, 8
    s_add_u32 s56, s56, 147456
    v_add_u32 v30, s56, v30
    v_lshlrev_b32 v120, 4, v1
    v_add_u32 v120, 131072, v120
    s_lshl_b32 s56, s49, 11
    v_add_u32 v121, s56, v120
    v_lshrrev_b32 v31, 3, v1
    v_mul_u32_u24 v31, 7168, v31
    v_and_b32 v4, 7, v0
    v_lshl_add_u32 v31, v4, 4, v31
    v_bfe_u32 v4, v0, 2, 2
    v_cmp_eq_u32 vcc, 0, v4
    s_nop 1
    v_cndmask_b32 v112, 0, -1, vcc
    v_cmp_eq_u32 vcc, 1, v4
    s_nop 1
    v_cndmask_b32 v113, 0, -1, vcc
    v_cmp_eq_u32 vcc, 2, v4
    s_nop 1
    v_cndmask_b32 v114, 0, -1, vcc
    v_cmp_eq_u32 vcc, 3, v4
    s_nop 1
    v_cndmask_b32 v115, 0, -1, vcc
    v_mov_b32 v5, s48
    v_mov_b32 v117, s48
    v_mov_b32 v119, s48
    s_mov_b32 s57, 32768
    s_branch L_g8_w
L_g8:
    buffer_load_dwordx4 v[104:107], v28, s[44:47], s70 offen offset:0 sc1
    buffer_load_dwordx4 v[108:111], v28, s[44:47], s70 offen offset:2048 sc1
L_g8_w:
    s_waitcnt vmcnt(1)
    v_bitop3_b32 v105, v105, v107, s48 bitop3:0x7e
    s_waitcnt vmcnt(0)
    v_bitop3_b32 v109, v109, v111, s48 bitop3:0x7e
    v_or_b32 v105, v105, v109
    v_cmp_ne_u32 vcc, 0, v105
    s_and_b64 exec, vcc, vcc
    s_cbranch_scc0 L_g8_x
    s_sub_u32 s57, s57, 1
    s_cbranch_scc0 L_g8
L_g8_x:
    s_mov_b64 exec, -1
    v_lshlrev_b32 v32, 16, v104
    v_and_b32 v33, 0xffff0000, v104
    v_lshlrev_b32 v34, 16, v106
    v_and_b32 v35, 0xffff0000, v106
    v_lshlrev_b32 v36, 16, v108
    v_and_b32 v37, 0xffff0000, v108
    v_lshlrev_b32 v38, 16, v110
    v_and_b32 v39, 0xffff0000, v110
    v_pk_add_f32 v[24:25], v[32:33], v[34:35]
    v_pk_mul_f32 v[26:27], v[32:33], v[32:33]
    v_pk_add_f32 v[24:25], v[24:25], v[36:37]
    v_pk_fma_f32 v[26:27], v[34:35], v[34:35], v[26:27]
    v_pk_add_f32 v[24:25], v[24:25], v[38:39]
    v_pk_fma_f32 v[26:27], v[36:37], v[36:37], v[26:27]
    v_add_f32 v24, v24, v25
    v_pk_fma_f32 v[26:27], v[38:39], v[38:39], v[26:27]
    v_add_f32 v26, v26, v27
    v_add_f32_dpp v24, v24, v24 quad_perm:[1,0,3,2] row_mask:0xf bank_mask:0xf
    s_nop 0
    v_add_f32_dpp v26, v26, v26 quad_perm:[1,0,3,2] row_mask:0xf bank_mask:0xf
    v_add_f32_dpp v24, v24, v24 quad_perm:[2,3,0,1] row_mask:0xf bank_mask:0xf
    s_nop 0
    v_add_f32_dpp v26, v26, v26 quad_perm:[2,3,0,1] row_mask:0xf bank_mask:0xf
    v_add_f32_dpp v24, v24, v24 row_half_mirror row_mask:0xf bank_mask:0xf
    s_nop 0
    v_add_f32_dpp v26, v26, v26 row_half_mirror row_mask:0xf bank_mask:0xf
    v_add_f32_dpp v24, v24, v24 row_ror:8 row_mask:0xf bank_mask:0xf
    s_nop 0
    v_add_f32_dpp v26, v26, v26 row_ror:8 row_mask:0xf bank_mask:0xf
    v_mov_b32 v25, v24
    v_mov_b32 v27, v26
    s_nop 0
    v_permlane16_swap_b32 v24, v25
    v_permlane16_swap_b32 v26, v27
    v_add_f32 v24, v24, v25
    v_add_f32 v26, v26, v27
    v_mov_b32 v25, v24
    v_mov_b32 v27, v26
    s_nop 0
    v_permlane32_swap_b32 v24, v25
    v_permlane32_swap_b32 v26, v27
    v_add_f32 v24, v24, v25
    v_add_f32 v26, v26, v27
    v_mul_f32 v24, 0x3b000000, v24
    v_mov_b32 v27, 0x3727c5ac
    v_fmac_f32 v27, 0x3b000000, v26
    v_mov_b32 v25, v24
    v_fma_f32 v27, -v24, v24, v27
    v_max_f32 v27, 0x3727c5ac, v27
    v_rsq_f32 v26, v27
    v_pk_add_f32 v[32:33], v[32:33], v[24:25] neg_lo:[0,1] neg_hi:[0,1]
    v_pk_add_f32 v[34:35], v[34:35], v[24:25] neg_lo:[0,1] neg_hi:[0,1]
    v_pk_add_f32 v[36:37], v[36:37], v[24:25] neg_lo:[0,1] neg_hi:[0,1]
    v_pk_add_f32 v[38:39], v[38:39], v[24:25] neg_lo:[0,1] neg_hi:[0,1]
    v_mov_b32 v27, v26
    v_pk_mul_f32 v[32:33], v[32:33], v[16:17]
    v_pk_mul_f32 v[34:35], v[34:35], v[18:19]
    v_pk_mul_f32 v[36:37], v[36:37], v[20:21]
    v_pk_mul_f32 v[38:39], v[38:39], v[22:23]
    v_pk_fma_f32 v[8:9], v[32:33], v[26:27], v[8:9]
    v_pk_fma_f32 v[10:11], v[34:35], v[26:27], v[10:11]
    v_pk_fma_f32 v[12:13], v[36:37], v[26:27], v[12:13]
    v_pk_fma_f32 v[14:15], v[38:39], v[26:27], v[14:15]
    v_cvt_pk_bf16_f32 v24, v8, v9
    v_cvt_pk_bf16_f32 v25, v10, v11
    v_cvt_pk_bf16_f32 v26, v12, v13
    v_cvt_pk_bf16_f32 v27, v14, v15
    ds_write_b64 v29, v[24:25]
    ds_write_b64 v29, v[26:27] offset:512
    s_waitcnt lgkmcnt(0)
    s_barrier
    ds_read_b128 v[136:139], v30 offset:0
    ds_read_b128 v[140:143], v30 offset:64
    ds_read_b128 v[144:147], v30 offset:128
    ds_read_b128 v[148:151], v30 offset:192
    s_waitcnt lgkmcnt(3)
    v_mfma_f32_16x16x32_bf16 v[8:11], v[40:43], v[136:139], 0
    v_mfma_f32_16x16x32_bf16 v[12:15], v[56:59], v[136:139], 0
    s_waitcnt lgkmcnt(2)
    v_mfma_f32_16x16x32_bf16 v[8:11], v[44:47], v[140:143], v[8:11]
    v_mfma_f32_16x16x32_bf16 v[12:15], v[60:63], v[140:143], v[12:15]
    s_waitcnt lgkmcnt(1)
    v_mfma_f32_16x16x32_bf16 v[8:11], v[48:51], v[144:147], v[8:11]
    v_mfma_f32_16x16x32_bf16 v[12:15], v[64:67], v[144:147], v[12:15]
    s_waitcnt lgkmcnt(0)
    v_mfma_f32_16x16x32_bf16 v[8:11], v[52:55], v[148:151], v[8:11]
    v_mfma_f32_16x16x32_bf16 v[12:15], v[68:71], v[148:151], v[12:15]
    s_nop 6
    ds_write_b128 v121, v[8:11]
    ds_write_b128 v121, v[12:15] offset:1024
    s_waitcnt lgkmcnt(0)
    s_barrier
    ds_read_b128 v[136:139], v120 offset:0
    ds_read_b128 v[140:143], v120 offset:1024
    ds_read_b128 v[144:147], v120 offset:2048
    ds_read_b128 v[148:151], v120 offset:3072
    ds_read_b128 v[152:155], v120 offset:4096
    ds_read_b128 v[156:159], v120 offset:5120
    ds_read_b128 v[160:163], v120 offset:6144
    ds_read_b128 v[164:167], v120 offset:7168
    s_waitcnt lgkmcnt(4)
    v_pk_add_f32 v[8:9], v[136:137], v[144:145]
    v_pk_add_f32 v[10:11], v[138:139], v[146:147]
    v_pk_add_f32 v[12:13], v[140:141], v[148:149]
    v_pk_add_f32 v[14:15], v[142:143], v[150:151]
    s_waitcnt lgkmcnt(0)
    v_pk_add_f32 v[152:153], v[152:153], v[160:161]
    v_pk_add_f32 v[154:155], v[154:155], v[162:163]
    v_pk_add_f32 v[156:157], v[156:157], v[164:165]
    v_pk_add_f32 v[158:159], v[158:159], v[166:167]
    v_pk_add_f32 v[8:9], v[8:9], v[152:153]
    v_pk_add_f32 v[10:11], v[10:11], v[154:155]
    v_pk_add_f32 v[12:13], v[12:13], v[156:157]
    v_pk_add_f32 v[14:15], v[14:15], v[158:159]
    v_mul_f32 v16, 0xbfb8aa3b, v8
    v_mul_f32 v17, 0xbfb8aa3b, v9
    v_mul_f32 v18, 0xbfb8aa3b, v10
    v_mul_f32 v19, 0xbfb8aa3b, v11
    v_mul_f32 v20, 0xbfb8aa3b, v12
    v_mul_f32 v21, 0xbfb8aa3b, v13
    v_mul_f32 v22, 0xbfb8aa3b, v14
    v_mul_f32 v23, 0xbfb8aa3b, v15
    v_exp_f32 v16, v16
    v_exp_f32 v17, v17
    v_exp_f32 v18, v18
    v_exp_f32 v19, v19
    v_exp_f32 v20, v20
    v_exp_f32 v21, v21
    v_exp_f32 v22, v22
    v_exp_f32 v23, v23
    v_add_f32 v16, 1.0, v16
    v_add_f32 v17, 1.0, v17
    v_add_f32 v18, 1.0, v18
    v_add_f32 v19, 1.0, v19
    v_add_f32 v20, 1.0, v20
    v_add_f32 v21, 1.0, v21
    v_add_f32 v22, 1.0, v22
    v_add_f32 v23, 1.0, v23
    v_rcp_f32 v16, v16
    v_rcp_f32 v17, v17
    v_rcp_f32 v18, v18
    v_rcp_f32 v19, v19
    v_rcp_f32 v20, v20
    v_rcp_f32 v21, v21
    v_rcp_f32 v22, v22
    v_rcp_f32 v23, v23
    v_mul_f32 v8, v8, v16
    v_mul_f32 v9, v9, v17
    v_mul_f32 v10, v10, v18
    v_mul_f32 v11, v11, v19
    v_mul_f32 v12, v12, v20
    v_mul_f32 v13, v13, v21
    v_mul_f32 v14, v14, v22
    v_mul_f32 v15, v15, v23
    v_cvt_pk_bf16_f32 v8, v8, v9
    v_cvt_pk_bf16_f32 v9, v10, v11
    v_cvt_pk_bf16_f32 v10, v12, v13
    v_cvt_pk_bf16_f32 v11, v14, v15
    v_and_b32 v136, v8, v112
    v_and_b32 v137, v9, v112
    v_and_b32 v138, v10, v112
    v_and_b32 v139, v11, v112
    v_and_b32 v140, v8, v113
    v_and_b32 v141, v9, v113
    v_and_b32 v142, v10, v113
    v_and_b32 v143, v11, v113
    v_mfma_f32_16x16x32_bf16 v[32:35], v[136:139], v[72:75], 0
    v_mfma_f32_16x16x32_bf16 v[36:39], v[136:139], v[88:91], 0
    v_and_b32 v144, v8, v114
    v_and_b32 v145, v9, v114
    v_and_b32 v146, v10, v114
    v_and_b32 v147, v11, v114
    v_mfma_f32_16x16x32_bf16 v[32:35], v[140:143], v[76:79], v[32:35]
    v_mfma_f32_16x16x32_bf16 v[36:39], v[140:143], v[92:95], v[36:39]
    v_and_b32 v148, v8, v115
    v_and_b32 v149, v9, v115
    v_and_b32 v150, v10, v115
    v_and_b32 v151, v11, v115
    v_mfma_f32_16x16x32_bf16 v[32:35], v[144:147], v[80:83], v[32:35]
    v_mfma_f32_16x16x32_bf16 v[36:39], v[144:147], v[96:99], v[36:39]
    v_mfma_f32_16x16x32_bf16 v[32:35], v[148:151], v[84:87], v[32:35]
    v_mfma_f32_16x16x32_bf16 v[36:39], v[148:151], v[100:103], v[36:39]
    s_nop 6
    v_cvt_pk_bf16_f32 v4, v32, v33
    v_cvt_pk_bf16_f32 v6, v34, v35
    buffer_store_dwordx4 v[4:7], v31, s[44:47], s73 offen sc1
    v_cvt_pk_bf16_f32 v116, v36, v37
    v_cvt_pk_bf16_f32 v118, v38, v39
    buffer_store_dwordx4 v[116:119], v31, s[44:47], s3 offen sc1
    s_branch L_done
L_t3:
    s_and_b32 s3, s51, 3
    s_lshl_b32 s56, s50, 2
    s_add_u32 s3, s3, s56
    v_bfe_u32 v30, v0, 1, 1
    v_lshlrev_b32 v30, 3, v30
    v_lshl_add_u32 v31, v2, 12, v30
    v_lshl_add_u32 v30, v2, 6, v30
    s_lshl_b32 s57, s49, 4
    s_lshl_b32 s56, s3, 8
    s_add_u32 s56, s56, s57
    s_add_u32 s72, s56, 45056
    s_lshr_b32 s53, s3, 3
    s_lshl_b32 s53, s53, 10
    s_and_b32 s56, s3, 3
    s_lshl_b32 s56, s56, 8
    s_add_u32 s53, s53, s56
    s_and_b32 s56, s3, 4
    s_lshl_b32 s56, s56, 4
    s_add_u32 s53, s53, s56
    s_lshr_b32 s56, s49, 1
    s_lshl_b32 s56, s56, 7
    s_add_u32 s53, s53, s56
    s_and_b32 s56, s57, 16
    s_add_u32 s53, s53, s56
    s_add_u32 s53, s53, 131072
    v_mov_b32 v29, v30
    s_mov_b32 s52, s72
    v_and_b32 v36, 1, v0
    v_lshlrev_b32 v36, 4, v36
    v_lshrrev_b32 v30, 2, v1
    v_lshlrev_b32 v30, 7, v30
    v_and_b32 v9, 3, v0
    v_lshl_add_u32 v30, v9, 4, v30
    v_and_b32 v37, 0x3ff, v30
    v_lshlrev_b32 v38, 10, v2
    v_lshl_add_u32 v38, v9, 1, v38
    s_lshl_b32 s72, s3, 1
    s_lshr_b32 s56, s49, 1
    s_add_u32 s72, s72, s56
    s_mul_i32 s72, s72, 7168
    s_and_b32 s56, s49, 1
    s_lshl_b32 s56, s56, 6
    s_add_u32 s72, s72, s56
    s_add_u32 s72, s72, 4194304
    s_add_u32 s73, s72, 4096
    s_add_u32 s74, s72, 8192
    s_add_u32 s75, s72, 12288
    s_lshl_b32 s3, s3, 5
    s_lshl_b32 s56, s49, 3
    s_add_u32 s3, s3, s56
    s_barrier
    ds_read_b128 v[8:11], v4 offset:0
    ds_read_b128 v[12:15], v4 offset:64
    ds_read_b128 v[16:19], v4 offset:128
    ds_read_b128 v[20:23], v4 offset:192
    ds_read_b128 v[32:35], v6
    s_waitcnt lgkmcnt(4)
    v_mfma_f32_16x16x32_bf16 v[24:27], v[8:11], v[40:43], 0
    s_waitcnt lgkmcnt(3)
    v_mfma_f32_16x16x32_bf16 v[24:27], v[12:15], v[44:47], v[24:27]
    s_waitcnt lgkmcnt(2)
    v_mfma_f32_16x16x32_bf16 v[24:27], v[16:19], v[48:51], v[24:27]
    s_waitcnt lgkmcnt(1)
    v_mfma_f32_16x16x32_bf16 v[24:27], v[20:23], v[52:55], v[24:27]
    s_waitcnt lgkmcnt(0)
    v_mfma_f32_16x16x32_bf16 v[40:43], v[8:11], v[56:59], 0
    v_mfma_f32_16x16x32_bf16 v[40:43], v[12:15], v[60:63], v[40:43]
    v_mfma_f32_16x16x32_bf16 v[40:43], v[16:19], v[64:67], v[40:43]
    v_mfma_f32_16x16x32_bf16 v[40:43], v[20:23], v[68:71], v[40:43]
    v_mfma_f32_16x16x32_bf16 v[56:59], v[8:11], v[72:75], 0
    v_mfma_f32_16x16x32_bf16 v[56:59], v[12:15], v[76:79], v[56:59]
    v_mfma_f32_16x16x32_bf16 v[56:59], v[16:19], v[80:83], v[56:59]
    v_mfma_f32_16x16x32_bf16 v[56:59], v[20:23], v[84:87], v[56:59]
    v_mfma_f32_16x16x32_bf16 v[72:75], v[8:11], v[88:91], 0
    v_mfma_f32_16x16x32_bf16 v[72:75], v[12:15], v[92:95], v[72:75]
    v_mfma_f32_16x16x32_bf16 v[72:75], v[16:19], v[96:99], v[72:75]
    v_mfma_f32_16x16x32_bf16 v[72:75], v[20:23], v[100:103], v[72:75]
    v_mfma_f32_16x16x32_bf16 v[88:91], v[8:11], v[104:107], 0
    v_mfma_f32_16x16x32_bf16 v[88:91], v[12:15], v[108:111], v[88:91]
    v_mfma_f32_16x16x32_bf16 v[88:91], v[16:19], v[112:115], v[88:91]
    v_mfma_f32_16x16x32_bf16 v[88:91], v[20:23], v[116:119], v[88:91]
    v_mfma_f32_16x16x32_bf16 v[104:107], v[8:11], v[120:123], 0
    v_mfma_f32_16x16x32_bf16 v[104:107], v[12:15], v[124:127], v[104:107]
    v_pk_mul_f32 v[24:25], v[24:25], v[32:33]
    v_pk_mul_f32 v[40:41], v[40:41], v[32:33]
    v_mfma_f32_16x16x32_bf16 v[104:107], v[16:19], v[128:131], v[104:107]
    v_pk_mul_f32 v[56:57], v[56:57], v[32:33]
    v_pk_mul_f32 v[72:73], v[72:73], v[32:33]
    v_mfma_f32_16x16x32_bf16 v[104:107], v[20:23], v[132:135], v[104:107]
    v_pk_fma_f32 v[24:25], v[26:27], v[34:35], v[24:25]
    v_pk_fma_f32 v[40:41], v[42:43], v[34:35], v[40:41]
    v_mfma_f32_16x16x32_bf16 v[120:123], v[8:11], v[136:139], 0
    v_pk_fma_f32 v[56:57], v[58:59], v[34:35], v[56:57]
    v_pk_fma_f32 v[72:73], v[74:75], v[34:35], v[72:73]
    v_mfma_f32_16x16x32_bf16 v[120:123], v[12:15], v[140:143], v[120:123]
    v_add_f32 v24, v24, v25
    v_add_f32 v40, v40, v41
    v_mfma_f32_16x16x32_bf16 v[120:123], v[16:19], v[144:147], v[120:123]
    v_add_f32 v56, v56, v57
    v_add_f32 v72, v72, v73
    v_mfma_f32_16x16x32_bf16 v[120:123], v[20:23], v[148:151], v[120:123]
    v_permlane16_swap_b32 v24, v40
    v_permlane16_swap_b32 v56, v72
    v_mfma_f32_16x16x32_bf16 v[136:139], v[8:11], v[152:155], 0
    v_add_f32 v24, v24, v40
    v_add_f32 v56, v56, v72
    v_mfma_f32_16x16x32_bf16 v[136:139], v[12:15], v[156:159], v[136:139]
    s_nop 0
    v_permlane32_swap_b32 v24, v56
    v_mfma_f32_16x16x32_bf16 v[136:139], v[16:19], v[160:163], v[136:139]
    v_mfma_f32_16x16x32_bf16 v[136:139], v[20:23], v[164:167], v[136:139]
    v_pk_mul_f32 v[88:89], v[88:89], v[32:33]
    v_pk_mul_f32 v[104:105], v[104:105], v[32:33]
    v_pk_mul_f32 v[120:121], v[120:121], v[32:33]
    s_nop 4
    v_pk_mul_f32 v[136:137], v[136:137], v[32:33]
    v_pk_fma_f32 v[88:89], v[90:91], v[34:35], v[88:89]
    v_pk_fma_f32 v[104:105], v[106:107], v[34:35], v[104:105]
    v_pk_fma_f32 v[120:121], v[122:123], v[34:35], v[120:121]
    v_pk_fma_f32 v[136:137], v[138:139], v[34:35], v[136:137]
    v_add_f32 v88, v88, v89
    v_add_f32 v104, v104, v105
    v_add_f32 v120, v120, v121
    v_add_f32 v136, v136, v137
    v_permlane16_swap_b32 v88, v104
    s_nop 0
    v_permlane16_swap_b32 v120, v136
    v_add_f32 v88, v88, v104
    v_add_f32 v120, v120, v136
    s_nop 1
    v_permlane32_swap_b32 v88, v120
    v_cvt_pk_bf16_f32 v6, v24, v88
    buffer_store_dwordx2 v[6:7], v5, s[44:47], s55 offen sc1
    buffer_load_dword v104, v30, s[44:47], s72 offen offset:0 sc1
    buffer_load_dword v105, v30, s[44:47], s72 offen offset:2048 sc1
    buffer_load_dword v106, v30, s[44:47], s73 offen offset:0 sc1
    buffer_load_dword v107, v37, s[44:47], s73 offen offset:2048 sc1
    s_mov_b64 s[58:59], -1
    s_mov_b64 s[60:61], -1
    s_mov_b32 s57, 32768
L_g10:
    s_mov_b64 exec, s[58:59]
    s_cbranch_execz L_g10_0
    buffer_load_dwordx2 v[32:33], v29, s[44:47], s52 offen offset:0 sc1
L_g10_0:
    s_mov_b64 exec, s[60:61]
    s_cbranch_execz L_g10_1
    buffer_load_dwordx2 v[34:35], v31, s[44:47], s53 offen offset:0 sc1
L_g10_1:
    s_waitcnt vmcnt(0)
    s_mov_b64 exec, s[58:59]
    v_cmp_ne_u32 s[58:59], s48, v33
    s_mov_b64 exec, s[60:61]
    v_cmp_ne_u32 s[60:61], s48, v35
    s_or_b64 s[100:101], s[58:59], s[58:59]
    s_or_b64 s[100:101], s[100:101], s[60:61]
    s_cbranch_scc0 L_g10_x
    s_sleep 2
    s_sub_u32 s57, s57, 1
    s_cbranch_scc0 L_g10
L_g10_x:
    s_mov_b64 exec, -1
    v_lshrrev_b32 v32, v36, v32
    v_lshlrev_b32 v32, 16, v32
    v_lshrrev_b32 v34, v36, v34
    v_lshlrev_b32 v34, 16, v34
    s_cmp_lg_u32 s3, 0
    s_cbranch_scc1 L_t3e
    v_lshlrev_b32 v8, 2, v1
    buffer_store_dword v7, v8, s[44:47], 0 offen sc1
L_t3e:
    s_mov_b32 s57, 32768
L_g11:
    buffer_load_dwordx4 v[104:107], v30, s[44:47], s72 offen offset:0 sc1
    buffer_load_dwordx4 v[108:111], v30, s[44:47], s72 offen offset:2048 sc1
    buffer_load_dwordx4 v[112:115], v30, s[44:47], s73 offen offset:0 sc1
    buffer_load_dwordx4 v[116:119], v37, s[44:47], s73 offen offset:2048 sc1
L_g11_w:
    s_waitcnt vmcnt(3)
    v_bitop3_b32 v105, v105, v107, s48 bitop3:0x7e
    s_waitcnt vmcnt(2)
    v_bitop3_b32 v109, v109, v111, s48 bitop3:0x7e
    s_waitcnt vmcnt(1)
    v_bitop3_b32 v113, v113, v115, s48 bitop3:0x7e
    v_or3_b32 v105, v105, v109, v113
    s_waitcnt vmcnt(0)
    v_bitop3_b32 v117, v117, v119, s48 bitop3:0x7e
    v_or_b32 v105, v105, v117
    v_cmp_ne_u32 vcc, 0, v105
    s_and_b64 exec, vcc, vcc
    s_cbranch_scc0 L_g11_x
    s_sub_u32 s57, s57, 1
    s_cbranch_scc0 L_g11
L_g11_x:
    s_mov_b64 exec, -1
    s_mov_b32 exec_lo, 0
    v_mov_b32 v116, 0
    v_mov_b32 v118, 0
    s_mov_b32 exec_lo, -1
    v_and_b32 v105, 0xffff0000, v104
    v_and_b32 v107, 0xffff0000, v106
    v_lshlrev_b32 v104, 16, v104
    v_lshlrev_b32 v106, 16, v106
    v_and_b32 v109, 0xffff0000, v108
    v_and_b32 v111, 0xffff0000, v110
    v_lshlrev_b32 v108, 16, v108
    v_lshlrev_b32 v110, 16, v110
    v_and_b32 v113, 0xffff0000, v112
    v_and_b32 v115, 0xffff0000, v114
    v_lshlrev_b32 v112, 16, v112
    v_lshlrev_b32 v114, 16, v114
    v_and_b32 v117, 0xffff0000, v116
    v_and_b32 v119, 0xffff0000, v118
    v_lshlrev_b32 v116, 16, v116
    v_lshlrev_b32 v118, 16, v118
    v_pk_add_f32 v[104:105], v[104:105], v[108:109]
    v_pk_add_f32 v[106:107], v[106:107], v[110:111]
    v_pk_add_f32 v[112:113], v[112:113], v[116:117]
    v_pk_add_f32 v[114:115], v[114:115], v[118:119]
    v_pk_add_f32 v[104:105], v[104:105], v[112:113]
    v_pk_add_f32 v[106:107], v[106:107], v[114:115]
    s_nop 0
    v_permlane16_swap_b32 v104, v105
    v_permlane16_swap_b32 v106, v107
    v_add_f32 v104, v104, v105
    v_add_f32 v106, v106, v107
    s_nop 1
    v_permlane32_swap_b32 v104, v106
    v_add_f32 v104, v104, v106
    s_nop 1
    v_add_f32_dpp v104, v104, v104 row_ror:4 row_mask:0xf bank_mask:0xf
    s_nop 1
    v_add_f32_dpp v104, v104, v104 row_ror:8 row_mask:0xf bank_mask:0xf
    v_fmac_f32 v34, v32, v104
    v_cvt_pk_bf16_f32 v34, v34, v34
    s_mov_b32 exec_lo, 0x000f000f
    s_mov_b32 exec_hi, 0x000f000f
    buffer_store_short v34, v38, s[40:43], s3 offen
    s_mov_b64 exec, -1
L_done:
L_end:
    s_endpgm
.fill (NCL*4096 + 128 - (. - L_beg))/4, 4, 0xbf810000
.section .rodata,"a"
.p2align 6
.amdhsa_kernel adaLN_cond__mha_block_cached__dense_activation_silu__decode_kernel
  .amdhsa_next_free_vgpr 168
  .amdhsa_next_free_sgpr 102
  .amdhsa_accum_offset 168
  .amdhsa_group_segment_fixed_size 0
  .amdhsa_kernarg_size 104
  .amdhsa_user_sgpr_count 2
  .amdhsa_user_sgpr_kernarg_segment_ptr 1
  .amdhsa_system_sgpr_workgroup_id_x 1
.end_amdhsa_kernel
```
